```python
import torch

def _softmax(x, axis=-1):
    return torch.softmax(x, dim=axis)
def _gelu(x):
    return torch.nn.functional.gelu(x, approximate="tanh")
def _silu(x):
    return torch.nn.functional.silu(x)
def _sigmoid(x):
    return torch.sigmoid(x)
def _layernorm(x, axis=-1, eps=1e-5):
    m = x.mean(dim=axis, keepdim=True)
    v = x.var(dim=axis, keepdim=True, unbiased=False)
    return (x - m) / torch.sqrt(v + eps)
def _scatter_add(tgt, idx, src, axis=0):
    return tgt.clone().index_add_(axis, idx, src)
def _segment_sum(src, seg, n):
    out = torch.zeros((n,) + src.shape[1:], dtype=src.dtype)
    return out.index_add_(0, seg, src)
def _pad(x, pw):
    flat = tuple(v for pair in reversed(pw) for v in pair)
    return torch.nn.functional.pad(x, flat)

kernel_name = 'recurrent_scan__ssm_conv_s4__glu_gated_glu__prompt'

def setup_inputs():

    _w = (lambda a: (lambda t: t.to(torch.bfloat16) if t.is_floating_point() else t)(torch.as_tensor(a)))
    def _A_setup():
        B, L, D, N = 1, 2048, 512, 128
        A_re = -(lambda _x: torch.exp(torch.as_tensor(_x)))((lambda *s: torch.randn(*s, dtype=torch.bfloat16) * 6.4)(D, N))
        A_im = torch.pi * (lambda *s: torch.randn(*s, dtype=torch.bfloat16) * 0.05)(D, N)
        B_re = (lambda *s: torch.randn(*s, dtype=torch.bfloat16) * 0.05)(D, N)
        B_im = (lambda *s: torch.randn(*s, dtype=torch.bfloat16) * 0.05)(D, N)
        C_re = (lambda *s: torch.randn(*s, dtype=torch.bfloat16) * 0.05)(D, N)
        C_im = (lambda *s: torch.randn(*s, dtype=torch.bfloat16) * 0.05)(D, N)
        log_dt = (lambda *s: torch.randn(*s, dtype=torch.bfloat16) * 0.05)(D) * 0.5 - 4.0
        Dskip = (lambda *s: torch.randn(*s, dtype=torch.bfloat16) * 0.05)(D)
        return {
            "u": _w((lambda *s: torch.randn(*s, dtype=torch.bfloat16) * 0.05)(B, L, D)),
            "A_re": _w(A_re),
            "A_im": _w(A_im),
            "B_re": _w(B_re),
            "B_im": _w(B_im),
            "C_re": _w(C_re),
            "C_im": _w(C_im),
            "log_dt": _w(log_dt),
            "Dskip": _w(Dskip),
        }
    _A_in = _A_setup()

    def _B_setup():
        B, S, D, F = 1, 2048, 512, 1792
        return {
            "x": _w((lambda *s: torch.randn(*s, dtype=torch.bfloat16) * 0.05)(B, S, D)),
            "w_gate": _w((lambda *s: torch.randn(*s, dtype=torch.bfloat16) * 0.05)(D, F)),
            "w_up": _w((lambda *s: torch.randn(*s, dtype=torch.bfloat16) * 0.05)(D, F)),
            "w_down": _w((lambda *s: torch.randn(*s, dtype=torch.bfloat16) * 0.05)(F, D)),
        }
    _B_in = _B_setup()

    return {
        "A_u": _A_in["u"],
        "A_A_re": _A_in["A_re"],
        "A_A_im": _A_in["A_im"],
        "A_B_re": _A_in["B_re"],
        "A_B_im": _A_in["B_im"],
        "A_C_re": _A_in["C_re"],
        "A_C_im": _A_in["C_im"],
        "A_log_dt": _A_in["log_dt"],
        "A_Dskip": _A_in["Dskip"],
        "B_x": _B_in["x"],
        "B_w_gate": _B_in["w_gate"],
        "B_w_up": _B_in["w_up"],
        "B_w_down": _B_in["w_down"],
    }

def reference(A_u, A_A_re, A_A_im, A_B_re, A_B_im, A_C_re, A_C_im, A_log_dt, A_Dskip, B_x, B_w_gate, B_w_up, B_w_down):
    def _A_ref(u, A_re, A_im, B_re, B_im, C_re, C_im, log_dt, Dskip):
        Bsz, L, D = u.shape
        dt = torch.exp(log_dt)[:, None]
        A = A_re + 1j * A_im
        Bc = B_re + 1j * B_im
        Cc = C_re + 1j * C_im
        logdA = dt * A
        dB = dt * Bc
        l = (lambda x, dt: x.to(dt))(torch.arange(L), A_re.dtype)
        P = torch.exp(logdA[:, :, None] * l[None, None, :])
        K = torch.einsum("dn,dnl,dn->dl", Cc, P, dB).real
        L2 = 2 * L
        Kp = _pad(K, ((0, 0), (0, L)))
        up = (lambda x, *d: x.permute(*d))(u, 0, 2, 1)
        up = _pad(up, ((0, 0), (0, 0), (0, L)))
        Kf = (lambda x, axes=(-2,-1): torch.fft.rfft2(x.float(), dim=axes))(Kp[:, None, :], axes=(-2, -1))
        Uf = (lambda x, axes=(-2,-1): torch.fft.rfft2(x.float(), dim=axes))(up[:, :, None, :], axes=(-2, -1))
        Yf = Uf * Kf[None, :, :, :]
        y = (lambda x, s, axes=(-2,-1): torch.fft.irfft2(x, s=s, dim=axes).to(torch.bfloat16))(Yf, (1, L2), axes=(-2, -1))[:, :, 0, :L]
        y = (lambda x, *d: x.permute(*d))(y, 0, 2, 1) + u * Dskip[None, None, :]
        return y

    def _B_ref(x, w_gate, w_up, w_down):
        g = torch.einsum("bsd,df->bsf", x, w_gate)
        u = torch.einsum("bsd,df->bsf", x, w_up)
        h = _sigmoid(g) * u
        return torch.einsum("bsf,fd->bsd", h, w_down)

    x = A_u
    xn = _layernorm(x, axis=-1)
    s = _A_ref(xn, A_A_re, A_A_im, A_B_re, A_B_im, A_C_re, A_C_im, A_log_dt, A_Dskip)
    g = _silu(_B_ref(xn, B_w_gate, B_w_up, B_w_down))
    return x + s * g
```

```asm
; @launch grid=(256,1,1) block=(512,1,1) lds=160512
.amdgcn_target "amdgcn-amd-amdhsa--gfx950"
.text
.globl recurrent_scan__ssm_conv_s4__glu_gated_glu__prompt_kernel
.p2align 8
.type recurrent_scan__ssm_conv_s4__glu_gated_glu__prompt_kernel,@function
recurrent_scan__ssm_conv_s4__glu_gated_glu__prompt_kernel:
    s_cmp_ge_u32 s2, 256
    s_cbranch_scc1 Lexit
    s_load_dwordx16 s[44:59], s[0:1], 0
    s_load_dwordx16 s[60:75], s[0:1], 64
    v_and_b32 v1, 63, v0
    v_lshrrev_b32 v4, 6, v0
    v_and_b32 v2, 15, v1
    v_lshrrev_b32 v3, 4, v1
    v_readfirstlane_b32 s3, v4
    v_lshlrev_b32 v5, 4, v1
    s_lshl_b32 s86, s2, 3
    s_nop 0
    s_add_u32 s86, s86, s3
    s_lshl_b32 s87, s86, 10
    s_waitcnt lgkmcnt(0)
    s_mov_b32 s8, s44
    s_and_b32 s9, s45, 0xffff
    s_mov_b32 s10, 2097152
    s_mov_b32 s11, 0x00020000
    buffer_load_dwordx4 v[10:13], v5, s[8:11], s87 offen
    s_mov_b32 s12, s74
    s_and_b32 s13, s75, 0xffff
    s_mov_b32 s14, 268435456
    s_mov_b32 s15, 0x00020000
    s_mov_b32 s28, s72
    s_and_b32 s29, s73, 0xffff
    s_mov_b32 s30, 256
    s_mov_b32 s31, 0x00020000
    v_mov_b32 v4, 0
    s_cmp_lg_u32 s2, 0
    s_cbranch_scc1 Linit_skip
    s_cmp_lg_u32 s3, 0
    s_cbranch_scc1 Linit_skip
    v_lshlrev_b32 v6, 8, v1
    v_mov_b32 v7, 0
    buffer_store_dword v7, v6, s[12:15], 0 offen sc1
    s_waitcnt vmcnt(0)
    v_mov_b32 v6, 1
    s_mov_b64 exec, 1
    buffer_store_dword v6, v7, s[28:31], 0 offen sc1
    s_mov_b64 exec, -1
Linit_skip:
    s_mov_b32 s16, s64
    s_and_b32 s17, s65, 0xffff
    s_mov_b32 s18, 1835008
    s_mov_b32 s19, 0x00020000
    s_mov_b32 s20, s66
    s_and_b32 s21, s67, 0xffff
    s_mov_b32 s22, 1835008
    s_mov_b32 s23, 0x00020000
    s_mov_b32 s24, s70
    s_and_b32 s25, s71, 0xffff
    s_mov_b32 s26, 2097152
    s_mov_b32 s27, 0x00020000
    s_mov_b32 s32, s68
    s_and_b32 s33, s69, 0xffff
    s_mov_b32 s34, 1835008
    s_mov_b32 s35, 0x00020000
    s_and_b32 s67, s2, 7
    s_lshl_b32 s67, s67, 5
    s_lshr_b32 s76, s2, 3
    s_add_u32 s67, s67, s76
    v_mov_b32 v63, 0
    v_lshlrev_b32 v62, 2, v1
    v_mov_b32 v63, 0
    s_lshl_b32 s76, s67, 9
    s_add_u32 s76, s76, 0
    s_lshl_b32 s78, s67, 2
    s_mov_b32 s36, s46
    s_and_b32 s37, s47, 0xffff
    s_mov_b32 s38, 131072
    s_mov_b32 s39, 0x00020000
    buffer_load_dword v48, v62, s[36:39], s76 offen
    s_mov_b32 s40, s48
    s_and_b32 s41, s49, 0xffff
    s_mov_b32 s42, 131072
    s_mov_b32 s43, 0x00020000
    buffer_load_dword v49, v62, s[40:43], s76 offen
    s_mov_b32 s36, s50
    s_and_b32 s37, s51, 0xffff
    s_mov_b32 s38, 131072
    s_mov_b32 s39, 0x00020000
    buffer_load_dword v50, v62, s[36:39], s76 offen
    s_mov_b32 s40, s52
    s_and_b32 s41, s53, 0xffff
    s_mov_b32 s42, 131072
    s_mov_b32 s43, 0x00020000
    buffer_load_dword v51, v62, s[40:43], s76 offen
    s_mov_b32 s36, s54
    s_and_b32 s37, s55, 0xffff
    s_mov_b32 s38, 131072
    s_mov_b32 s39, 0x00020000
    buffer_load_dword v52, v62, s[36:39], s76 offen
    s_mov_b32 s40, s56
    s_and_b32 s41, s57, 0xffff
    s_mov_b32 s42, 131072
    s_mov_b32 s43, 0x00020000
    buffer_load_dword v53, v62, s[40:43], s76 offen
    s_mov_b32 s36, s58
    s_and_b32 s37, s59, 0xffff
    s_mov_b32 s38, 1024
    s_mov_b32 s39, 0x00020000
    buffer_load_dword v60, v63, s[36:39], s78 offen
    s_mov_b32 s40, s60
    s_and_b32 s41, s61, 0xffff
    s_mov_b32 s42, 1024
    s_mov_b32 s43, 0x00020000
    buffer_load_dword v61, v63, s[40:43], s78 offen
    s_waitcnt vmcnt(63)
    v_mov_b32 v200, 150016
    v_mov_b32 v201, 0
    v_lshl_add_u32 v200, v2, 2, v200
    ds_write_b32 v200, v201
    s_waitcnt vmcnt(8)
    v_mov_b32 v63, 0
    s_and_b32 s76, s2, 7
    s_lshr_b32 s77, s2, 3
    s_lshr_b32 s78, s76, 1
    s_lshl_b32 s78, s78, 2
    s_lshr_b32 s79, s77, 3
    s_add_u32 s78, s78, s79
    s_mul_i32 s78, s78, 224
    s_and_b32 s79, s77, 7
    s_mul_i32 s79, s79, 229376
    s_add_u32 s78, s78, s79
    v_mul_u32_u24 v251, 3584, v1
    s_mov_b32 s79, 0
    s_cmp_eq_u32 s3, 1
    s_cselect_b32 s79, 128, s79
    s_cmp_eq_u32 s3, 2
    s_cselect_b32 s79, 220, s79
    s_cmp_eq_u32 s3, 4
    s_cselect_b32 s79, 128, s79
    s_cmp_eq_u32 s3, 5
    s_cselect_b32 s79, 220, s79
    s_add_u32 s78, s78, s79
    s_lshl_b32 s76, s2, 12
    s_cmp_ge_u32 s3, 7
    s_cbranch_scc1 Lt7
    s_cmp_ge_u32 s3, 6
    s_cbranch_scc1 Lt6
    s_cmp_ge_u32 s3, 3
    s_cbranch_scc1 Lt3
    buffer_load_dword v250, v251, s[16:19], s78 offen
    s_branch Ltj
Lt3:
    buffer_load_dword v250, v251, s[20:23], s78 offen
    s_branch Ltj
Lt6:
    buffer_load_dword v250, v63, s[32:35], s76 offen
    s_branch Ltj
Lt7:
    buffer_load_dword v250, v63, s[24:27], s76 offen
Ltj:
    v_lshlrev_b32 v20, 16, v10
    v_and_b32 v21, 0xffff0000, v10
    v_lshlrev_b32 v22, 16, v11
    v_and_b32 v23, 0xffff0000, v11
    v_lshlrev_b32 v24, 16, v12
    v_and_b32 v25, 0xffff0000, v12
    v_lshlrev_b32 v26, 16, v13
    v_and_b32 v27, 0xffff0000, v13
    v_add_f32 v28, v20, v21
    v_add_f32 v29, v22, v23
    v_add_f32 v30, v24, v25
    v_add_f32 v31, v26, v27
    v_add_f32 v28, v28, v29
    v_add_f32 v30, v30, v31
    v_add_f32 v28, v28, v30
    s_nop 1
    v_add_f32_dpp v28, v28, v28 quad_perm:[1,0,3,2] row_mask:0xf bank_mask:0xf
    s_nop 1
    v_add_f32_dpp v28, v28, v28 quad_perm:[2,3,0,1] row_mask:0xf bank_mask:0xf
    s_nop 1
    v_add_f32_dpp v28, v28, v28 row_half_mirror row_mask:0xf bank_mask:0xf
    s_nop 1
    v_add_f32_dpp v28, v28, v28 row_mirror row_mask:0xf bank_mask:0xf
    v_mov_b32 v29, v28
    s_nop 1
    v_permlane16_swap_b32 v28, v29
    v_add_f32 v28, v28, v29
    v_mov_b32 v29, v28
    s_nop 1
    v_permlane32_swap_b32 v28, v29
    v_add_f32 v28, v28, v29
    v_mul_f32 v28, 0x3b000000, v28
    v_sub_f32 v30, v20, v28
    v_mul_f32 v31, v30, v30
    v_sub_f32 v30, v21, v28
    v_fmac_f32 v31, v30, v30
    v_sub_f32 v30, v22, v28
    v_fmac_f32 v31, v30, v30
    v_sub_f32 v30, v23, v28
    v_fmac_f32 v31, v30, v30
    v_sub_f32 v30, v24, v28
    v_fmac_f32 v31, v30, v30
    v_sub_f32 v30, v25, v28
    v_fmac_f32 v31, v30, v30
    v_sub_f32 v30, v26, v28
    v_fmac_f32 v31, v30, v30
    v_sub_f32 v30, v27, v28
    v_fmac_f32 v31, v30, v30
    s_nop 1
    v_add_f32_dpp v31, v31, v31 quad_perm:[1,0,3,2] row_mask:0xf bank_mask:0xf
    s_nop 1
    v_add_f32_dpp v31, v31, v31 quad_perm:[2,3,0,1] row_mask:0xf bank_mask:0xf
    s_nop 1
    v_add_f32_dpp v31, v31, v31 row_half_mirror row_mask:0xf bank_mask:0xf
    s_nop 1
    v_add_f32_dpp v31, v31, v31 row_mirror row_mask:0xf bank_mask:0xf
    v_mov_b32 v29, v31
    s_nop 1
    v_permlane16_swap_b32 v31, v29
    v_add_f32 v31, v31, v29
    v_mov_b32 v29, v31
    s_nop 1
    v_permlane32_swap_b32 v31, v29
    v_add_f32 v31, v31, v29
    v_mul_f32 v31, 0x3b000000, v31
    v_cvt_pk_bf16_f32 v28, v28, v28
    v_lshlrev_b32 v28, 16, v28
    v_cvt_pk_bf16_f32 v31, v31, v31
    v_lshlrev_b32 v31, 16, v31
    v_add_f32 v31, 0x3727c5ac, v31
    v_cvt_pk_bf16_f32 v31, v31, v31
    v_lshlrev_b32 v31, 16, v31
    v_sqrt_f32 v31, v31
    s_nop 0
    v_cvt_pk_bf16_f32 v31, v31, v31
    v_lshlrev_b32 v31, 16, v31
    v_rcp_f32 v32, v31
    v_sub_f32 v20, v20, v28
    v_sub_f32 v21, v21, v28
    v_sub_f32 v22, v22, v28
    v_sub_f32 v23, v23, v28
    v_sub_f32 v24, v24, v28
    v_sub_f32 v25, v25, v28
    v_sub_f32 v26, v26, v28
    v_sub_f32 v27, v27, v28
    v_cvt_pk_bf16_f32 v33, v20, v21
    v_lshlrev_b32 v20, 16, v33
    v_and_b32 v21, 0xffff0000, v33
    v_cvt_pk_bf16_f32 v33, v22, v23
    v_lshlrev_b32 v22, 16, v33
    v_and_b32 v23, 0xffff0000, v33
    v_cvt_pk_bf16_f32 v33, v24, v25
    v_lshlrev_b32 v24, 16, v33
    v_and_b32 v25, 0xffff0000, v33
    v_cvt_pk_bf16_f32 v33, v26, v27
    v_lshlrev_b32 v26, 16, v33
    v_and_b32 v27, 0xffff0000, v33
    v_mul_f32 v33, v20, v32
    v_fma_f32 v34, -v33, v31, v20
    v_fma_f32 v20, v34, v32, v33
    v_mul_f32 v33, v21, v32
    v_fma_f32 v34, -v33, v31, v21
    v_fma_f32 v21, v34, v32, v33
    v_mul_f32 v33, v22, v32
    v_fma_f32 v34, -v33, v31, v22
    v_fma_f32 v22, v34, v32, v33
    v_mul_f32 v33, v23, v32
    v_fma_f32 v34, -v33, v31, v23
    v_fma_f32 v23, v34, v32, v33
    v_mul_f32 v33, v24, v32
    v_fma_f32 v34, -v33, v31, v24
    v_fma_f32 v24, v34, v32, v33
    v_mul_f32 v33, v25, v32
    v_fma_f32 v34, -v33, v31, v25
    v_fma_f32 v25, v34, v32, v33
    v_mul_f32 v33, v26, v32
    v_fma_f32 v34, -v33, v31, v26
    v_fma_f32 v26, v34, v32, v33
    v_mul_f32 v33, v27, v32
    v_fma_f32 v34, -v33, v31, v27
    v_fma_f32 v27, v34, v32, v33
    v_cvt_pk_bf16_f32 v10, v20, v21
    v_cvt_pk_bf16_f32 v11, v22, v23
    v_cvt_pk_bf16_f32 v12, v24, v25
    v_cvt_pk_bf16_f32 v13, v26, v27
    s_mul_i32 s91, s3, 1040
    s_add_u32 s91, s91, 122880
    v_add_u32 v9, s91, v5
    ds_write_b128 v9, v[10:13]
    v_and_b32 v6, 7, v0
    v_lshrrev_b32 v9, 3, v0
    v_mul_u32_u24 v33, 1040, v6
    v_lshl_add_u32 v33, v9, 4, v33
    v_add_u32 v33, 122880, v33
    v_lshlrev_b32 v34, 8, v9
    v_lshl_add_u32 v34, v6, 4, v34
    s_lshr_b32 s91, s2, 1
    s_mul_i32 s91, s91, 16640
    s_and_b32 s92, s2, 1
    s_lshl_b32 s92, s92, 7
    s_add_u32 s91, s91, s92
    s_add_u32 s91, s91, 1048576
    s_waitcnt lgkmcnt(0)
    s_barrier
    ds_read_b128 v[40:43], v33
    s_waitcnt lgkmcnt(0)
    buffer_store_dwordx4 v[40:43], v34, s[12:15], s91 offen sc1
    v_mov_b32 v7, 0
    buffer_load_dword v8, v7, s[28:31], 0 offen sc1
    s_and_b32 s76, s2, 7
    s_lshr_b32 s77, s2, 3
    s_and_b32 s78, s76, 1
    s_lshl_b32 s78, s78, 3
    s_and_b32 s79, s77, 7
    s_add_u32 s4, s78, s79
    s_lshr_b32 s78, s76, 1
    s_lshl_b32 s78, s78, 2
    s_lshr_b32 s79, s77, 3
    s_add_u32 s5, s78, s79
    s_mul_i32 s6, s5, 224
    s_mul_i32 s7, s3, 896
    s_and_b32 s78, s3, 4
    s_and_b32 s79, s3, 1
    s_lshl_b32 s79, s79, 1
    s_or_b32 s78, s78, s79
    s_lshr_b32 s79, s3, 1
    s_and_b32 s79, s79, 1
    s_or_b32 s78, s78, s79
    s_lshl_b32 s78, s78, 2
    v_mul_u32_u24 v18, 147, v1
    v_lshrrev_b32 v18, 11, v18
    v_mul_u32_u24 v19, 14, v18
    v_sub_u32 v19, v1, v19
    v_add_u32 v18, s78, v18
    v_mul_u32_u24 v18, 3584, v18
    v_lshl_add_u32 v18, v19, 4, v18
    s_min_u32 s88, s3, 6
    s_mul_i32 s89, s2, 7
    s_add_u32 s88, s88, s89
    s_lshr_b32 s89, s88, 5
    s_and_b32 s90, s88, 31
    s_mul_i32 s91, s89, 37
    s_lshr_b32 s91, s91, 8
    s_mul_i32 s92, s91, 7
    s_sub_u32 s92, s89, s92
    s_mul_i32 s91, s91, 224
    s_lshl_b32 s93, s92, 5
    s_add_u32 s91, s91, s93
    s_cmp_ge_u32 s92, 3
    s_cselect_b32 s93, 16, 0
    s_add_u32 s89, s91, s93
    s_add_u32 s93, s89, 16
    s_sub_u32 s94, s91, 96
    s_add_u32 s95, s91, 16
    s_cmp_eq_u32 s92, 6
    s_cselect_b32 s89, s94, s89
    s_cselect_b32 s93, s95, s93
    s_lshl_b32 s90, s90, 5
    s_lshl_b32 s89, s89, 10
    s_lshl_b32 s93, s93, 10
    s_add_u32 s89, s89, s90
    s_add_u32 s90, s93, s90
    v_lshlrev_b32 v19, 12, v3
    v_lshl_add_u32 v19, v2, 1, v19
    s_mov_b32 s66, s88
    s_mov_b32 s62, s89
    s_mov_b32 s63, s90
    s_and_b32 s76, s3, 1
    s_lshl_b32 s77, s76, 4
    s_lshr_b32 s78, s3, 1
    s_mov_b32 s79, 0
    s_mov_b32 s80, 0x41800000
    s_mov_b32 s81, 0
    s_mov_b32 s82, 1.0
    s_cmp_eq_u32 s78, 1
    s_cselect_b32 s79, 0x43800000, s79
    s_cselect_b32 s81, 0x41000000, s81
    s_cmp_eq_u32 s78, 2
    s_cselect_b32 s79, 0x44000000, s79
    s_cselect_b32 s80, 0x42000000, s80
    s_cselect_b32 s81, 0x41800000, s81
    s_cselect_b32 s82, 4.0, s82
    s_cmp_eq_u32 s78, 3
    s_cselect_b32 s79, 0x44800000, s79
    s_cselect_b32 s80, 0x42800000, s80
    s_cselect_b32 s81, 0x42000000, s81
    s_cselect_b32 s82, 0x41000000, s82
    s_cmp_eq_u32 s76, 1
    s_cselect_b64 s[84:85], -1, 0
    s_lshl_b32 s86, s76, 8
    s_mul_i32 s87, s78, 4224
    s_add_u32 s86, s86, 57344
    s_add_u32 s87, s87, s86
    s_mul_i32 s88, s78, 8448
    s_add_u32 s88, s88, s86
    s_add_u32 s88, s88, 16896
    v_lshl_add_u32 v30, v1, 2, s87
    v_lshl_add_u32 v31, v1, 2, s88
    s_mov_b32 s92, 0
    s_cmp_ge_u32 s3, 1
    s_cselect_b32 s92, 1, s92
    s_cmp_ge_u32 s3, 2
    s_cselect_b32 s92, 2, s92
    s_cmp_ge_u32 s3, 4
    s_cselect_b32 s92, 3, s92
    s_lshl_b32 s93, 128, s92
    s_cmp_eq_u32 s92, 0
    s_cselect_b32 s93, 0, s93
    s_lshl_b32 s94, 8, s92
    s_max_u32 s94, s94, 16
    s_lshl_b32 s95, 1, s92
    s_lshr_b32 s95, s95, 1
    s_sub_u32 s95, s3, s95
    s_lshl_b32 s95, s95, 4
    s_add_u32 s96, s93, s95
    v_add_u32 v32, s96, v2
    v_cvt_f32_u32 v32, v32
    v_cvt_pk_bf16_f32 v32, v32, v32
    v_lshlrev_b32 v32, 16, v32
    v_cvt_u32_f32 v32, v32
    v_subrev_u32 v32, s93, v32
    v_lshrrev_b32 v36, 2, v32
    v_add_u32 v36, 12, v36
    v_lshrrev_b32 v37, 3, v32
    v_add_u32 v37, 20, v37
    v_cmp_lt_u32 vcc, 32, v32
    s_nop 1
    v_cndmask_b32 v36, v36, v37, vcc
    v_cmp_gt_u32 vcc, 16, v32
    s_nop 1
    v_cndmask_b32 v32, v36, v32, vcc
    v_mul_u32_u24 v32, 528, v32
    v_lshl_add_u32 v32, v3, 4, v32
    v_add_u32 v32, 57344, v32
    s_lshl_b32 s97, s92, 4
    s_add_u32 s97, s97, 32
    v_add_u32 v33, s97, v2
    v_mul_u32_u24 v33, 528, v33
    v_lshl_add_u32 v33, v3, 4, v33
    v_add_u32 v33, 57344, v33
    v_mul_lo_u32 v34, v2, s94
    v_lshl_add_u32 v34, v3, 2, v34
    v_add_u32 v34, s96, v34
    v_add_u32 v34, 16, v34
    v_add_u32 v35, 4, v34
    v_lshrrev_b32 v35, 6, v35
    v_lshlrev_b32 v35, 3, v35
    v_lshl_add_u32 v35, v34, 1, v35
    v_add_u32 v35, 114688, v35
    v_lshrrev_b32 v36, 6, v34
    v_lshlrev_b32 v36, 3, v36
    v_lshl_add_u32 v34, v34, 1, v36
    v_add_u32 v34, 114688, v34
    s_waitcnt vmcnt(0)
    v_readfirstlane_b32 s89, v61
    v_readfirstlane_b32 s74, v60
    s_barrier
    s_cmp_lg_u32 s3, 0
    s_cbranch_scc1 LsigA_skip
    v_readfirstlane_b32 s76, v8
    s_nop 2
    s_cmp_lg_u32 s76, 0
    s_cbranch_scc1 LsigA_go
    v_mov_b32 v10, 0
    s_mov_b32 s99, 0
LsigA_poll:
    buffer_load_dword v11, v10, s[28:31], 0 offen sc1
    s_waitcnt vmcnt(0)
    v_cmp_gt_u32 vcc, 1, v11
    s_nop 4
    s_cbranch_vccz LsigA_poll_ok
    s_sleep 1
    s_add_u32 s99, s99, 1
    s_cmp_lt_u32 s99, 0x8000
    s_cbranch_scc1 LsigA_poll
LsigA_poll_ok:
LsigA_go:
    s_lshr_b32 s76, s2, 4
    s_lshl_b32 s76, s76, 8
    s_add_u32 s76, s76, 0
    v_mov_b32 v10, s76
    v_mov_b32 v11, 1
    s_mov_b64 exec, 1
    buffer_atomic_add v11, v10, s[12:15], 0 offen sc1
    s_mov_b64 exec, -1
LsigA_skip:
    s_lshl_b32 s68, s74, 16
    v_mov_b32 v192, s68
    s_add_u32 s75, s6, 0
    s_add_u32 m0, s7, 0
    s_mov_b32 exec_hi, 0x00ffffff
    buffer_load_dwordx4 v18, s[16:19], s75 offen lds
    s_mov_b32 exec_hi, -1
    v_mul_f32 v192, 1069066811, v192
    v_exp_f32 v192, v192
    s_nop 0
    v_cvt_pk_bf16_f32 v192, v192, v192
    v_lshlrev_b32 v192, 16, v192
    v_lshlrev_b32 v194, 16, v50
    v_and_b32 v195, 0xffff0000, v50
    v_lshlrev_b32 v196, 16, v51
    s_add_u32 s75, s6, 0
    s_add_u32 m0, s7, 7168
    s_mov_b32 exec_hi, 0x00ffffff
    buffer_load_dwordx4 v18, s[20:23], s75 offen lds
    s_mov_b32 exec_hi, -1
    v_and_b32 v197, 0xffff0000, v51
    v_lshlrev_b32 v198, 16, v52
    v_and_b32 v199, 0xffff0000, v52
    v_lshlrev_b32 v200, 16, v53
    v_and_b32 v201, 0xffff0000, v53
    v_mul_f32 v194, v192, v194
    v_mul_f32 v195, v192, v195
    v_mul_f32 v196, v192, v196
    s_add_u32 s75, s6, 114688
    s_add_u32 m0, s7, 14336
    s_mov_b32 exec_hi, 0x00ffffff
    buffer_load_dwordx4 v18, s[16:19], s75 offen lds
    s_mov_b32 exec_hi, -1
    v_mul_f32 v197, v192, v197
    v_mul_f32 v202, v198, v194
    v_mul_f32 v203, v198, v196
    v_mul_f32 v204, v199, v195
    v_mul_f32 v205, v199, v197
    v_fma_f32 v202, -v200, v196, v202
    v_fma_f32 v203, v200, v194, v203
    v_fma_f32 v204, -v201, v197, v204
    s_add_u32 s75, s6, 114688
    s_add_u32 m0, s7, 21504
    s_mov_b32 exec_hi, 0x00ffffff
    buffer_load_dwordx4 v18, s[20:23], s75 offen lds
    s_mov_b32 exec_hi, -1
    v_fma_f32 v205, v201, v195, v205
    v_max3_f32 v206, abs(v202), abs(v203), abs(v204)
    v_max_f32 v206, abs(v205), v206
    s_nop 1
    v_max_f32_dpp v206, v206, v206 quad_perm:[1,0,3,2] row_mask:0xf bank_mask:0xf
    s_nop 1
    v_max_f32_dpp v206, v206, v206 quad_perm:[2,3,0,1] row_mask:0xf bank_mask:0xf
    s_nop 1
    v_max_f32_dpp v206, v206, v206 row_half_mirror row_mask:0xf bank_mask:0xf
    s_nop 1
    v_max_f32_dpp v206, v206, v206 row_mirror row_mask:0xf bank_mask:0xf
    v_mov_b32 v207, v206
    s_add_u32 s75, s6, 229376
    s_add_u32 m0, s7, 28672
    s_mov_b32 exec_hi, 0x00ffffff
    buffer_load_dwordx4 v18, s[16:19], s75 offen lds
    s_mov_b32 exec_hi, -1
    v_permlane16_swap_b32 v206, v207
    v_max_f32 v206, v206, v207
    v_mov_b32 v207, v206
    s_nop 1
    v_permlane32_swap_b32 v206, v207
    v_max_f32 v206, v206, v207
    v_lshrrev_b32 v206, 23, v206
    v_max_u32 v206, 8, v206
    v_min_u32 v206, 250, v206
    s_add_u32 s75, s6, 229376
    s_add_u32 m0, s7, 35840
    s_mov_b32 exec_hi, 0x00ffffff
    buffer_load_dwordx4 v18, s[20:23], s75 offen lds
    s_mov_b32 exec_hi, -1
    v_sub_u32 v207, 261, v206
    v_lshlrev_b32 v207, 23, v207
    v_subrev_u32 v206, 7, v206
    v_lshlrev_b32 v206, 23, v206
    s_nop 0
    v_readfirstlane_b32 s90, v206
    v_cndmask_b32 v202, v202, v204, s[84:85]
    v_cndmask_b32 v203, v203, v205, s[84:85]
    v_mul_f32 v202, v202, v207
    s_add_u32 s75, s6, 344064
    s_add_u32 m0, s7, 43008
    s_mov_b32 exec_hi, 0x00ffffff
    buffer_load_dwordx4 v18, s[16:19], s75 offen lds
    s_mov_b32 exec_hi, -1
    v_mul_f32 v203, v203, v207
    v_lshrrev_b32 v194, s77, v48
    v_lshlrev_b32 v194, 16, v194
    v_lshrrev_b32 v195, s77, v49
    v_lshlrev_b32 v195, 16, v195
    v_mul_f32 v194, v192, v194
    v_mul_f32 v195, v192, v195
    v_mul_f32 v194, 1069066811, v194
    s_add_u32 s75, s6, 344064
    s_add_u32 m0, s7, 50176
    s_mov_b32 exec_hi, 0x00ffffff
    buffer_load_dwordx4 v18, s[20:23], s75 offen lds
    s_mov_b32 exec_hi, -1
    v_mul_f32 v195, 1042479491, v195
    v_mul_f32 v220, s81, v194
    v_mul_f32 v221, s81, v195
    v_exp_f32 v220, v220
    v_fract_f32 v221, v221
    v_cos_f32 v222, v221
    v_sin_f32 v223, v221
    v_mul_f32 v208, v220, v222
    v_mul_f32 v209, v220, v223
    v_mul_f32 v224, s82, v194
    v_mul_f32 v225, s82, v195
    v_exp_f32 v224, v224
    v_fract_f32 v225, v225
    v_cos_f32 v226, v225
    v_sin_f32 v227, v225
    v_mul_f32 v210, v224, v226
    v_mul_f32 v211, v224, v227
    v_mul_f32 v228, s79, v194
    v_mul_f32 v229, s79, v195
    v_exp_f32 v228, v228
    v_fract_f32 v229, v229
    v_cos_f32 v230, v229
    v_sin_f32 v231, v229
    v_mul_f32 v212, v228, v230
    v_mul_f32 v213, v228, v231
    v_mul_f32 v232, s80, v194
    v_mul_f32 v233, s80, v195
    v_exp_f32 v232, v232
    v_fract_f32 v233, v233
    v_cos_f32 v234, v233
    v_sin_f32 v235, v233
    v_mul_f32 v214, v232, v234
    v_mul_f32 v215, v232, v235
    v_pk_mul_f32 v[236:237], v[202:203], v[212:213] op_sel:[0,0] op_sel_hi:[1,0]
    v_pk_fma_f32 v[216:217], v[202:203], v[212:213], v[236:237] op_sel:[1,1,0] op_sel_hi:[0,1,1] neg_lo:[1,0,0]
    v_pk_mul_f32 v[238:239], v[216:217], v[214:215] op_sel:[0,0] op_sel_hi:[1,0]
    v_pk_fma_f32 v[218:219], v[216:217], v[214:215], v[238:239] op_sel:[1,1,0] op_sel_hi:[0,1,1] neg_lo:[1,0,0]
    v_pk_mul_f32 v[240:241], v[214:215], v[214:215] op_sel:[0,0] op_sel_hi:[1,0]
    v_pk_fma_f32 v[212:213], v[214:215], v[214:215], v[240:241] op_sel:[1,1,0] op_sel_hi:[0,1,1] neg_lo:[1,0,0]
    v_cvt_pk_f16_f32 v242, v208, v209
    ds_write_b32 v30, v242 offset:0
    v_cvt_pk_f16_f32 v243, v216, -v217
    ds_write_b32 v31, v243 offset:0
    v_cvt_pk_f16_f32 v244, v218, -v219
    ds_write_b32 v31, v244 offset:528
    v_pk_mul_f32 v[236:237], v[208:209], v[210:211] op_sel:[0,0] op_sel_hi:[1,0]
    v_pk_fma_f32 v[208:209], v[208:209], v[210:211], v[236:237] op_sel:[1,1,0] op_sel_hi:[0,1,1] neg_lo:[1,0,0]
    v_pk_mul_f32 v[238:239], v[216:217], v[212:213] op_sel:[0,0] op_sel_hi:[1,0]
    v_pk_fma_f32 v[216:217], v[216:217], v[212:213], v[238:239] op_sel:[1,1,0] op_sel_hi:[0,1,1] neg_lo:[1,0,0]
    v_pk_mul_f32 v[240:241], v[218:219], v[212:213] op_sel:[0,0] op_sel_hi:[1,0]
    v_pk_fma_f32 v[218:219], v[218:219], v[212:213], v[240:241] op_sel:[1,1,0] op_sel_hi:[0,1,1] neg_lo:[1,0,0]
    v_cvt_pk_f16_f32 v242, v208, v209
    ds_write_b32 v30, v242 offset:528
    v_cvt_pk_f16_f32 v243, v216, -v217
    ds_write_b32 v31, v243 offset:1056
    v_cvt_pk_f16_f32 v244, v218, -v219
    ds_write_b32 v31, v244 offset:1584
    v_pk_mul_f32 v[236:237], v[208:209], v[210:211] op_sel:[0,0] op_sel_hi:[1,0]
    v_pk_fma_f32 v[208:209], v[208:209], v[210:211], v[236:237] op_sel:[1,1,0] op_sel_hi:[0,1,1] neg_lo:[1,0,0]
    v_pk_mul_f32 v[238:239], v[216:217], v[212:213] op_sel:[0,0] op_sel_hi:[1,0]
    v_pk_fma_f32 v[216:217], v[216:217], v[212:213], v[238:239] op_sel:[1,1,0] op_sel_hi:[0,1,1] neg_lo:[1,0,0]
    v_pk_mul_f32 v[240:241], v[218:219], v[212:213] op_sel:[0,0] op_sel_hi:[1,0]
    v_pk_fma_f32 v[218:219], v[218:219], v[212:213], v[240:241] op_sel:[1,1,0] op_sel_hi:[0,1,1] neg_lo:[1,0,0]
    v_cvt_pk_f16_f32 v242, v208, v209
    ds_write_b32 v30, v242 offset:1056
    v_cvt_pk_f16_f32 v243, v216, -v217
    ds_write_b32 v31, v243 offset:2112
    v_cvt_pk_f16_f32 v244, v218, -v219
    ds_write_b32 v31, v244 offset:2640
    v_pk_mul_f32 v[236:237], v[208:209], v[210:211] op_sel:[0,0] op_sel_hi:[1,0]
    v_pk_fma_f32 v[208:209], v[208:209], v[210:211], v[236:237] op_sel:[1,1,0] op_sel_hi:[0,1,1] neg_lo:[1,0,0]
    v_pk_mul_f32 v[238:239], v[216:217], v[212:213] op_sel:[0,0] op_sel_hi:[1,0]
    v_pk_fma_f32 v[216:217], v[216:217], v[212:213], v[238:239] op_sel:[1,1,0] op_sel_hi:[0,1,1] neg_lo:[1,0,0]
    v_pk_mul_f32 v[240:241], v[218:219], v[212:213] op_sel:[0,0] op_sel_hi:[1,0]
    v_pk_fma_f32 v[218:219], v[218:219], v[212:213], v[240:241] op_sel:[1,1,0] op_sel_hi:[0,1,1] neg_lo:[1,0,0]
    v_cvt_pk_f16_f32 v242, v208, v209
    ds_write_b32 v30, v242 offset:1584
    v_cvt_pk_f16_f32 v243, v216, -v217
    ds_write_b32 v31, v243 offset:3168
    v_cvt_pk_f16_f32 v244, v218, -v219
    ds_write_b32 v31, v244 offset:3696
    v_pk_mul_f32 v[236:237], v[208:209], v[210:211] op_sel:[0,0] op_sel_hi:[1,0]
    v_pk_fma_f32 v[208:209], v[208:209], v[210:211], v[236:237] op_sel:[1,1,0] op_sel_hi:[0,1,1] neg_lo:[1,0,0]
    v_pk_mul_f32 v[238:239], v[216:217], v[212:213] op_sel:[0,0] op_sel_hi:[1,0]
    v_pk_fma_f32 v[216:217], v[216:217], v[212:213], v[238:239] op_sel:[1,1,0] op_sel_hi:[0,1,1] neg_lo:[1,0,0]
    v_pk_mul_f32 v[240:241], v[218:219], v[212:213] op_sel:[0,0] op_sel_hi:[1,0]
    v_pk_fma_f32 v[218:219], v[218:219], v[212:213], v[240:241] op_sel:[1,1,0] op_sel_hi:[0,1,1] neg_lo:[1,0,0]
    v_cvt_pk_f16_f32 v242, v208, v209
    ds_write_b32 v30, v242 offset:2112
    v_cvt_pk_f16_f32 v243, v216, -v217
    ds_write_b32 v31, v243 offset:4224
    v_cvt_pk_f16_f32 v244, v218, -v219
    ds_write_b32 v31, v244 offset:4752
    v_pk_mul_f32 v[236:237], v[208:209], v[210:211] op_sel:[0,0] op_sel_hi:[1,0]
    v_pk_fma_f32 v[208:209], v[208:209], v[210:211], v[236:237] op_sel:[1,1,0] op_sel_hi:[0,1,1] neg_lo:[1,0,0]
    v_pk_mul_f32 v[238:239], v[216:217], v[212:213] op_sel:[0,0] op_sel_hi:[1,0]
    v_pk_fma_f32 v[216:217], v[216:217], v[212:213], v[238:239] op_sel:[1,1,0] op_sel_hi:[0,1,1] neg_lo:[1,0,0]
    v_pk_mul_f32 v[240:241], v[218:219], v[212:213] op_sel:[0,0] op_sel_hi:[1,0]
    v_pk_fma_f32 v[218:219], v[218:219], v[212:213], v[240:241] op_sel:[1,1,0] op_sel_hi:[0,1,1] neg_lo:[1,0,0]
    v_cvt_pk_f16_f32 v242, v208, v209
    ds_write_b32 v30, v242 offset:2640
    v_cvt_pk_f16_f32 v243, v216, -v217
    ds_write_b32 v31, v243 offset:5280
    v_cvt_pk_f16_f32 v244, v218, -v219
    ds_write_b32 v31, v244 offset:5808
    v_pk_mul_f32 v[236:237], v[208:209], v[210:211] op_sel:[0,0] op_sel_hi:[1,0]
    v_pk_fma_f32 v[208:209], v[208:209], v[210:211], v[236:237] op_sel:[1,1,0] op_sel_hi:[0,1,1] neg_lo:[1,0,0]
    v_pk_mul_f32 v[238:239], v[216:217], v[212:213] op_sel:[0,0] op_sel_hi:[1,0]
    v_pk_fma_f32 v[216:217], v[216:217], v[212:213], v[238:239] op_sel:[1,1,0] op_sel_hi:[0,1,1] neg_lo:[1,0,0]
    v_pk_mul_f32 v[240:241], v[218:219], v[212:213] op_sel:[0,0] op_sel_hi:[1,0]
    v_pk_fma_f32 v[218:219], v[218:219], v[212:213], v[240:241] op_sel:[1,1,0] op_sel_hi:[0,1,1] neg_lo:[1,0,0]
    v_cvt_pk_f16_f32 v242, v208, v209
    ds_write_b32 v30, v242 offset:3168
    v_cvt_pk_f16_f32 v243, v216, -v217
    ds_write_b32 v31, v243 offset:6336
    v_cvt_pk_f16_f32 v244, v218, -v219
    ds_write_b32 v31, v244 offset:6864
    v_pk_mul_f32 v[236:237], v[208:209], v[210:211] op_sel:[0,0] op_sel_hi:[1,0]
    v_pk_fma_f32 v[208:209], v[208:209], v[210:211], v[236:237] op_sel:[1,1,0] op_sel_hi:[0,1,1] neg_lo:[1,0,0]
    v_pk_mul_f32 v[238:239], v[216:217], v[212:213] op_sel:[0,0] op_sel_hi:[1,0]
    v_pk_fma_f32 v[216:217], v[216:217], v[212:213], v[238:239] op_sel:[1,1,0] op_sel_hi:[0,1,1] neg_lo:[1,0,0]
    v_pk_mul_f32 v[240:241], v[218:219], v[212:213] op_sel:[0,0] op_sel_hi:[1,0]
    v_pk_fma_f32 v[218:219], v[218:219], v[212:213], v[240:241] op_sel:[1,1,0] op_sel_hi:[0,1,1] neg_lo:[1,0,0]
    v_cvt_pk_f16_f32 v242, v208, v209
    ds_write_b32 v30, v242 offset:3696
    v_cvt_pk_f16_f32 v243, v216, -v217
    ds_write_b32 v31, v243 offset:7392
    v_cvt_pk_f16_f32 v244, v218, -v219
    ds_write_b32 v31, v244 offset:7920
    s_waitcnt lgkmcnt(0)
    s_barrier
    s_cmp_lg_u32 s3, 0
    s_cbranch_scc1 Lkz_skip0
    v_mul_u32_u24 v36, 4416, v3
    v_lshl_add_u32 v36, v2, 1, v36
    v_add_u32 v36, 114688, v36
    v_mov_b32 v37, 0
    ds_write_b16 v36, v37
    v_cmp_gt_u32 vcc, v3, v2
    s_nop 2
    s_and_saveexec_b64 s[96:97], vcc
    ds_write_b16 v36, v37 offset:32
    s_mov_b64 exec, s[96:97]
Lkz_skip0:
    ds_read_b128 v[192:195], v32 offset:0
    ds_read_b128 v[196:199], v33 offset:0
    ds_read_b128 v[200:203], v32 offset:64
    ds_read_b128 v[204:207], v33 offset:64
    ds_read_b128 v[208:211], v32 offset:128
    ds_read_b128 v[212:215], v33 offset:128
    ds_read_b128 v[216:219], v32 offset:192
    ds_read_b128 v[220:223], v33 offset:192
    s_waitcnt lgkmcnt(6)
    v_mfma_f32_16x16x32_f16 v[244:247], v[192:195], v[196:199], 0
    s_waitcnt lgkmcnt(4)
    v_mfma_f32_16x16x32_f16 v[244:247], v[200:203], v[204:207], v[244:247]
    s_waitcnt lgkmcnt(2)
    v_mfma_f32_16x16x32_f16 v[244:247], v[208:211], v[212:215], v[244:247]
    s_waitcnt lgkmcnt(0)
    v_mfma_f32_16x16x32_f16 v[244:247], v[216:219], v[220:223], v[244:247]
    ds_read_b128 v[192:195], v32 offset:256
    ds_read_b128 v[196:199], v33 offset:256
    ds_read_b128 v[200:203], v32 offset:320
    ds_read_b128 v[204:207], v33 offset:320
    ds_read_b128 v[208:211], v32 offset:384
    ds_read_b128 v[212:215], v33 offset:384
    ds_read_b128 v[216:219], v32 offset:448
    ds_read_b128 v[220:223], v33 offset:448
    s_waitcnt lgkmcnt(6)
    v_mfma_f32_16x16x32_f16 v[244:247], v[192:195], v[196:199], v[244:247]
    s_waitcnt lgkmcnt(4)
    v_mfma_f32_16x16x32_f16 v[244:247], v[200:203], v[204:207], v[244:247]
    s_waitcnt lgkmcnt(2)
    v_mfma_f32_16x16x32_f16 v[244:247], v[208:211], v[212:215], v[244:247]
    s_waitcnt lgkmcnt(0)
    v_mfma_f32_16x16x32_f16 v[244:247], v[216:219], v[220:223], v[244:247]
    s_nop 7
    v_cvt_pk_f16_f32 v236, v244, v245
    v_cvt_pk_f16_f32 v237, v246, v247
    v_alignbit_b32 v238, v237, v236, 16
    ds_write_b64 v34, v[236:237] offset:0
    ds_write_b16 v34, v236 offset:4418
    ds_write_b32 v34, v238 offset:4420
    ds_write_b16_d16_hi v35, v237 offset:4424
    ds_write_b32 v34, v236 offset:8836
    ds_write_b32 v35, v237 offset:8840
    ds_write_b16 v34, v236 offset:13254
    ds_write_b32 v35, v238 offset:13256
    ds_write_b16_d16_hi v35, v237 offset:13260
    s_waitcnt lgkmcnt(0)
    s_cmp_lg_u32 s3, 0
    s_cbranch_scc1 LwaitA_skip
    v_lshlrev_b32 v10, 8, v2
    v_add_u32 v10, 0, v10
    s_mov_b32 s99, 0
LwaitA:
    buffer_load_dword v11, v10, s[12:15], 0 offen sc1
    s_waitcnt vmcnt(0)
    v_cmp_gt_u32 vcc, 16, v11
    s_nop 4
    s_cbranch_vccz LwaitA_ok
    s_sleep 1
    s_add_u32 s99, s99, 1
    s_cmp_lt_u32 s99, 0x8000
    s_cbranch_scc1 LwaitA
LwaitA_ok:
LwaitA_skip:
    s_barrier
    s_lshl_b32 s77, s67, 1
    s_lshr_b32 s78, s77, 5
    s_lshl_b32 s78, s78, 10
    s_lshr_b32 s79, s77, 3
    s_and_b32 s79, s79, 3
    s_lshl_b32 s79, s79, 8
    s_add_u32 s78, s78, s79
    s_and_b32 s79, s77, 7
    s_lshl_b32 s79, s79, 1
    s_add_u32 s78, s78, s79
    s_mul_i32 s79, s3, 266240
    s_add_u32 s78, s78, s79
    s_add_u32 s78, s78, 1048576
    v_mul_u32_u24 v6, 16640, v3
    v_lshl_add_u32 v6, v2, 4, v6
    s_add_u32 s79, s78, 66560
    s_add_u32 s80, s78, 133120
    s_add_u32 s81, s78, 199680
    buffer_load_dword v28, v6, s[12:15], s78 offen sc1
    buffer_load_dword v29, v6, s[12:15], s79 offen sc1
    buffer_load_dword v30, v6, s[12:15], s80 offen sc1
    buffer_load_dword v31, v6, s[12:15], s81 offen sc1
    s_lshl_b32 s69, s4, 3
    s_add_u32 s69, s69, s3
    s_mul_i32 s69, s69, 16640
    s_add_u32 s69, s69, 1048576
    s_add_u32 s70, s69, 0
    buffer_load_dwordx4 v[64:67], v5, s[12:15], s70 offen offset:0 sc1
    buffer_load_dwordx4 v[68:71], v5, s[12:15], s70 offen offset:1024 sc1
    buffer_load_dwordx4 v[72:75], v5, s[12:15], s70 offen offset:2048 sc1
    buffer_load_dwordx4 v[76:79], v5, s[12:15], s70 offen offset:3072 sc1
    v_sub_u32 v23, 3, v2
    v_and_b32 v23, 3, v23
    v_mul_u32_u24 v20, 4416, v23
    v_add_u32 v23, v23, v2
    v_lshlrev_b32 v24, 3, v3
    v_sub_u32 v23, v23, v24
    v_add_u32 v23, 25, v23
    v_lshl_add_u32 v20, v23, 1, v20
    s_lshl_b32 s87, s3, 6
    s_add_u32 s87, s87, 114688
    v_add_u32 v20, s87, v20
    s_lshl_b32 s88, s3, 5
    v_add_u32 v23, s88, v23
    v_add_u32 v24, 4, v23
    v_lshrrev_b32 v24, 6, v24
    v_lshl_add_u32 v21, v24, 3, v20
    v_add_u32 v21, 8, v21
    v_lshrrev_b32 v23, 6, v23
    v_lshl_add_u32 v20, v23, 3, v20
    v_lshlrev_b32 v22, 5, v2
    v_lshl_add_u32 v22, v3, 4, v22
    s_lshl_b32 s88, s3, 6
    s_add_u32 s88, s88, 150800
    v_sub_u32 v22, s88, v22
    s_waitcnt vmcnt(4)
    s_lshl_b32 s77, s3, 9
    s_sub_u32 s77, 154366, s77
    v_lshlrev_b32 v6, 1, v1
    v_sub_u32 v6, s77, v6
    v_subrev_u32 v6, 384, v6
    v_lshlrev_b32 v7, 16, v28
    v_and_b32 v8, 0xffff0000, v28
    v_cvt_pk_f16_f32 v7, v7, v8
    ds_write_b16 v6, v7 offset:384
    ds_write_b16_d16_hi v6, v7 offset:5504
    v_lshlrev_b32 v7, 16, v29
    v_and_b32 v8, 0xffff0000, v29
    v_cvt_pk_f16_f32 v7, v7, v8
    ds_write_b16 v6, v7 offset:256
    ds_write_b16_d16_hi v6, v7 offset:5376
    v_lshlrev_b32 v7, 16, v30
    v_and_b32 v8, 0xffff0000, v30
    v_cvt_pk_f16_f32 v7, v7, v8
    ds_write_b16 v6, v7 offset:128
    ds_write_b16_d16_hi v6, v7 offset:5248
    v_lshlrev_b32 v7, 16, v31
    v_and_b32 v8, 0xffff0000, v31
    v_cvt_pk_f16_f32 v7, v7, v8
    ds_write_b16 v6, v7 offset:0
    ds_write_b16_d16_hi v6, v7 offset:5120
    v_lshlrev_b32 v6, 2, v1
    v_add_u32 v6, 154368, v6
    v_mov_b32 v7, 0
    ds_write_b32 v6, v7
    ds_write_b32 v6, v7 offset:256
    ds_write_b32 v6, v7 offset:5120
    ds_write_b32 v6, v7 offset:5376
    s_waitcnt lgkmcnt(0)
    s_barrier
    ds_read_b64 v[192:193], v20 offset:0
    ds_read_b64 v[194:195], v21 offset:0
    ds_read_b128 v[224:227], v22 offset:3584
    ds_read_b64 v[196:197], v20 offset:544
    ds_read_b64 v[198:199], v21 offset:544
    ds_read_b128 v[228:231], v22 offset:3072
    ds_read_b64 v[200:201], v20 offset:1088
    ds_read_b64 v[202:203], v21 offset:1088
    ds_read_b128 v[232:235], v22 offset:2560
    ds_read_b64 v[204:205], v20 offset:1632
    ds_read_b64 v[206:207], v21 offset:1632
    ds_read_b128 v[236:239], v22 offset:2048
    ds_read_b64 v[208:209], v20 offset:2176
    ds_read_b64 v[210:211], v21 offset:2176
    ds_read_b128 v[240:243], v22 offset:1536
    ds_read_b64 v[212:213], v20 offset:2720
    ds_read_b64 v[214:215], v21 offset:2720
    ds_read_b128 v[244:247], v22 offset:1024
    ds_read_b64 v[216:217], v20 offset:3264
    ds_read_b64 v[218:219], v21 offset:3264
    ds_read_b128 v[248:251], v22 offset:512
    ds_read_b64 v[220:221], v20 offset:3808
    ds_read_b64 v[222:223], v21 offset:3808
    ds_read_b128 v[252:255], v22 offset:0
    s_add_u32 s70, s69, 4096
    buffer_load_dwordx4 v[80:83], v5, s[12:15], s70 offen offset:0 sc1
    s_waitcnt lgkmcnt(15)
    v_mfma_f32_16x16x32_f16 v[32:35], v[192:195], v[224:227], 0
    s_waitcnt lgkmcnt(15)
    v_mfma_f32_16x16x32_f16 v[36:39], v[192:195], v[228:231], 0
    buffer_load_dwordx4 v[84:87], v5, s[12:15], s70 offen offset:1024 sc1
    v_mfma_f32_16x16x32_f16 v[36:39], v[196:199], v[224:227], v[36:39]
    v_mfma_f32_16x16x32_f16 v[40:43], v[196:199], v[228:231], 0
    s_waitcnt lgkmcnt(15)
    v_mfma_f32_16x16x32_f16 v[40:43], v[192:195], v[232:235], v[40:43]
    buffer_load_dwordx4 v[88:91], v5, s[12:15], s70 offen offset:2048 sc1
    v_mfma_f32_16x16x32_f16 v[40:43], v[200:203], v[224:227], v[40:43]
    v_mfma_f32_16x16x32_f16 v[44:47], v[196:199], v[232:235], 0
    v_mfma_f32_16x16x32_f16 v[44:47], v[200:203], v[228:231], v[44:47]
    v_mfma_f32_16x16x32_f16 v[48:51], v[200:203], v[232:235], 0
    buffer_load_dwordx4 v[92:95], v5, s[12:15], s70 offen offset:3072 sc1
    s_waitcnt lgkmcnt(12)
    v_mfma_f32_16x16x32_f16 v[44:47], v[192:195], v[236:239], v[44:47]
    v_mfma_f32_16x16x32_f16 v[44:47], v[204:207], v[224:227], v[44:47]
    v_mfma_f32_16x16x32_f16 v[48:51], v[196:199], v[236:239], v[48:51]
    s_add_u32 s70, s69, 8192
    buffer_load_dwordx4 v[96:99], v5, s[12:15], s70 offen offset:0 sc1
    v_mfma_f32_16x16x32_f16 v[48:51], v[204:207], v[228:231], v[48:51]
    v_mfma_f32_16x16x32_f16 v[52:55], v[200:203], v[236:239], 0
    v_mfma_f32_16x16x32_f16 v[52:55], v[204:207], v[232:235], v[52:55]
    v_mfma_f32_16x16x32_f16 v[56:59], v[204:207], v[236:239], 0
    buffer_load_dwordx4 v[100:103], v5, s[12:15], s70 offen offset:1024 sc1
    s_waitcnt lgkmcnt(9)
    v_mfma_f32_16x16x32_f16 v[48:51], v[192:195], v[240:243], v[48:51]
    v_mfma_f32_16x16x32_f16 v[48:51], v[208:211], v[224:227], v[48:51]
    v_mfma_f32_16x16x32_f16 v[52:55], v[196:199], v[240:243], v[52:55]
    buffer_load_dwordx4 v[104:107], v5, s[12:15], s70 offen offset:2048 sc1
    v_mfma_f32_16x16x32_f16 v[52:55], v[208:211], v[228:231], v[52:55]
    v_mfma_f32_16x16x32_f16 v[56:59], v[200:203], v[240:243], v[56:59]
    v_mfma_f32_16x16x32_f16 v[56:59], v[208:211], v[232:235], v[56:59]
    v_mfma_f32_16x16x32_f16 v[60:63], v[204:207], v[240:243], 0
    buffer_load_dwordx4 v[108:111], v5, s[12:15], s70 offen offset:3072 sc1
    v_mfma_f32_16x16x32_f16 v[60:63], v[208:211], v[236:239], v[60:63]
    s_waitcnt lgkmcnt(6)
    v_mfma_f32_16x16x32_f16 v[52:55], v[192:195], v[244:247], v[52:55]
    v_mfma_f32_16x16x32_f16 v[52:55], v[212:215], v[224:227], v[52:55]
    v_mfma_f32_16x16x32_f16 v[56:59], v[196:199], v[244:247], v[56:59]
    v_mfma_f32_16x16x32_f16 v[56:59], v[212:215], v[228:231], v[56:59]
    v_mfma_f32_16x16x32_f16 v[60:63], v[200:203], v[244:247], v[60:63]
    v_mfma_f32_16x16x32_f16 v[60:63], v[212:215], v[232:235], v[60:63]
    s_waitcnt lgkmcnt(3)
    v_mfma_f32_16x16x32_f16 v[56:59], v[192:195], v[248:251], v[56:59]
    v_mfma_f32_16x16x32_f16 v[56:59], v[216:219], v[224:227], v[56:59]
    v_mfma_f32_16x16x32_f16 v[60:63], v[196:199], v[248:251], v[60:63]
    v_mfma_f32_16x16x32_f16 v[60:63], v[216:219], v[228:231], v[60:63]
    s_waitcnt lgkmcnt(0)
    v_mfma_f32_16x16x32_f16 v[60:63], v[192:195], v[252:255], v[60:63]
    v_mfma_f32_16x16x32_f16 v[60:63], v[220:223], v[224:227], v[60:63]
    s_mul_i32 s84, s3, 7168
    s_add_u32 s84, s84, 57344
    v_add_u32 v6, s84, v5
    s_lshl_b32 s84, s3, 10
    s_add_u32 s84, s84, 132352
    v_add_u32 v7, s84, v5
    ds_write_b128 v6, v[32:35] offset:0
    ds_write_b128 v6, v[36:39] offset:1024
    ds_write_b128 v6, v[40:43] offset:2048
    ds_write_b128 v6, v[44:47] offset:3072
    ds_write_b128 v6, v[48:51] offset:4096
    ds_write_b128 v6, v[52:55] offset:5120
    ds_write_b128 v6, v[56:59] offset:6144
    ds_write_b128 v7, v[60:63]
    s_lshl_b32 s84, s3, 10
    s_add_u32 s84, s84, 57344
    s_mov_b32 s85, 7168
    s_cmp_eq_u32 s3, 7
    s_cselect_b32 s84, 132352, s84
    s_cselect_b32 s85, 1024, s85
    v_add_u32 v7, s84, v5
    v_lshlrev_b32 v14, 4, v2
    v_lshl_add_u32 v14, v3, 2, v14
    s_lshl_b32 s86, s3, 8
    v_add_u32 v14, s86, v14
    v_lshlrev_b32 v15, 1, v14
    v_sub_u32 v16, 154360, v15
    ds_read_b64 v[24:25], v16
    s_lshl_b32 s79, s67, 1
    s_add_u32 s79, s79, 0
    s_lshl_b32 s80, s79, 12
    s_add_u32 s88, s80, 33554432
    s_lshl_b32 s86, s89, 16
    s_waitcnt lgkmcnt(0)
    s_barrier
    ds_read_b128 v[192:195], v7
    v_add_u32 v7, s85, v7
    ds_read_b128 v[196:199], v7
    v_add_u32 v7, s85, v7
    ds_read_b128 v[200:203], v7
    v_add_u32 v7, s85, v7
    ds_read_b128 v[204:207], v7
    v_add_u32 v7, s85, v7
    ds_read_b128 v[208:211], v7
    v_add_u32 v7, s85, v7
    ds_read_b128 v[212:215], v7
    v_add_u32 v7, s85, v7
    ds_read_b128 v[216:219], v7
    v_add_u32 v7, s85, v7
    ds_read_b128 v[220:223], v7
    s_waitcnt lgkmcnt(0)
    s_barrier
    s_add_u32 s75, s6, 458752
    s_add_u32 m0, s7, 57344
    s_mov_b32 exec_hi, 0x00ffffff
    buffer_load_dwordx4 v18, s[16:19], s75 offen lds
    s_mov_b32 exec_hi, -1
    s_add_u32 s75, s6, 458752
    s_add_u32 m0, s7, 64512
    s_mov_b32 exec_hi, 0x00ffffff
    buffer_load_dwordx4 v18, s[20:23], s75 offen lds
    s_mov_b32 exec_hi, -1
    s_add_u32 s75, s6, 573440
    s_add_u32 m0, s7, 71680
    s_mov_b32 exec_hi, 0x00ffffff
    buffer_load_dwordx4 v18, s[16:19], s75 offen lds
    s_mov_b32 exec_hi, -1
    s_add_u32 s75, s6, 573440
    s_add_u32 m0, s7, 78848
    s_mov_b32 exec_hi, 0x00ffffff
    buffer_load_dwordx4 v18, s[20:23], s75 offen lds
    s_mov_b32 exec_hi, -1
    s_add_u32 s75, s6, 688128
    s_add_u32 m0, s7, 86016
    s_mov_b32 exec_hi, 0x00ffffff
    buffer_load_dwordx4 v18, s[16:19], s75 offen lds
    s_mov_b32 exec_hi, -1
    s_add_u32 s75, s6, 688128
    s_add_u32 m0, s7, 93184
    s_mov_b32 exec_hi, 0x00ffffff
    buffer_load_dwordx4 v18, s[20:23], s75 offen lds
    s_mov_b32 exec_hi, -1
    s_add_u32 s75, s6, 802816
    s_add_u32 m0, s7, 100352
    s_mov_b32 exec_hi, 0x00ffffff
    buffer_load_dwordx4 v18, s[16:19], s75 offen lds
    s_mov_b32 exec_hi, -1
    s_add_u32 s75, s6, 802816
    s_add_u32 m0, s7, 107520
    s_mov_b32 exec_hi, 0x00ffffff
    buffer_load_dwordx4 v18, s[20:23], s75 offen lds
    s_mov_b32 exec_hi, -1
    s_add_u32 s70, s69, 12288
    buffer_load_dwordx4 v[112:115], v5, s[12:15], s70 offen offset:0 sc1
    buffer_load_dwordx4 v[116:119], v5, s[12:15], s70 offen offset:1024 sc1
    buffer_load_dwordx4 v[120:123], v5, s[12:15], s70 offen offset:2048 sc1
    buffer_load_dwordx4 v[124:127], v5, s[12:15], s70 offen offset:3072 sc1
    v_add_f32 v192, v192, v196
    v_add_f32 v200, v200, v204
    v_add_f32 v208, v208, v212
    v_add_f32 v216, v216, v220
    v_add_f32 v192, v192, v200
    v_add_f32 v208, v208, v216
    v_add_f32 v192, v192, v208
    v_mul_f32 v192, s90, v192
    v_add_f32 v193, v193, v197
    v_add_f32 v201, v201, v205
    v_add_f32 v209, v209, v213
    v_add_f32 v217, v217, v221
    v_add_f32 v193, v193, v201
    v_add_f32 v209, v209, v217
    v_add_f32 v193, v193, v209
    v_mul_f32 v193, s90, v193
    v_add_f32 v194, v194, v198
    v_add_f32 v202, v202, v206
    v_add_f32 v210, v210, v214
    v_add_f32 v218, v218, v222
    v_add_f32 v194, v194, v202
    v_add_f32 v210, v210, v218
    v_add_f32 v194, v194, v210
    v_mul_f32 v194, s90, v194
    v_add_f32 v195, v195, v199
    v_add_f32 v203, v203, v207
    v_add_f32 v211, v211, v215
    v_add_f32 v219, v219, v223
    v_add_f32 v195, v195, v203
    v_add_f32 v211, v211, v219
    v_add_f32 v195, v195, v211
    v_mul_f32 v195, s90, v195
    v_cvt_f32_f16 v20, v25
    v_lshrrev_b32 v21, 16, v25
    v_cvt_f32_f16 v21, v21
    v_cvt_f32_f16 v22, v24
    v_lshrrev_b32 v23, 16, v24
    v_cvt_f32_f16 v23, v23
    v_mul_f32 v21, s86, v21
    v_mul_f32 v20, s86, v20
    v_mul_f32 v23, s86, v23
    v_mul_f32 v22, s86, v22
    v_cvt_pk_bf16_f32 v24, v21, v20
    v_cvt_pk_bf16_f32 v25, v23, v22
    v_cvt_pk_bf16_f32 v26, v192, v193
    v_cvt_pk_bf16_f32 v27, v194, v195
    v_lshlrev_b32 v20, 16, v24
    v_and_b32 v21, 0xffff0000, v24
    v_lshlrev_b32 v22, 16, v25
    v_and_b32 v23, 0xffff0000, v25
    v_lshlrev_b32 v28, 16, v26
    v_and_b32 v29, 0xffff0000, v26
    v_lshlrev_b32 v30, 16, v27
    v_and_b32 v31, 0xffff0000, v27
    v_add_f32 v20, v20, v28
    v_add_f32 v21, v21, v29
    v_add_f32 v22, v22, v30
    v_add_f32 v23, v23, v31
    v_cvt_pk_bf16_f32 v12, v20, v21
    v_cvt_pk_bf16_f32 v13, v22, v23
    buffer_store_dwordx2 v[12:13], v15, s[12:15], s88 offen sc1
    s_and_b32 s96, s2, 7
    s_lshr_b32 s97, s2, 3
    s_lshl_b32 s96, s96, 2
    s_and_b32 s98, s97, 3
    s_add_u32 s64, s96, s98
    s_lshr_b32 s65, s97, 2
    v_lshrrev_b32 v24, 1, v3
    v_lshlrev_b32 v24, 4, v24
    v_and_b32 v25, 1, v3
    v_lshl_add_u32 v24, v25, 2, v24
    v_lshrrev_b32 v25, 2, v2
    v_add_u32 v24, v24, v25
    v_mul_u32_u24 v24, 224, v24
    v_and_b32 v25, 3, v2
    v_lshl_add_u32 v24, v25, 3, v24
    v_add_u32 v25, 28672, v24
    v_add_u32 v26, 57344, v24
    v_add_u32 v27, 86016, v24
    s_waitcnt vmcnt(28)
    s_barrier
    ds_read_b64_tr_b16 v[32:33], v24 offset:0
    ds_read_b64_tr_b16 v[34:35], v24 offset:1792
    ds_read_b64_tr_b16 v[36:37], v24 offset:7168
    ds_read_b64_tr_b16 v[38:39], v24 offset:8960
    ds_read_b64_tr_b16 v[40:41], v24 offset:32
    ds_read_b64_tr_b16 v[42:43], v24 offset:1824
    ds_read_b64_tr_b16 v[44:45], v24 offset:7200
    ds_read_b64_tr_b16 v[46:47], v24 offset:8992
    ds_read_b64_tr_b16 v[48:49], v24 offset:64
    ds_read_b64_tr_b16 v[50:51], v24 offset:1856
    ds_read_b64_tr_b16 v[52:53], v24 offset:7232
    ds_read_b64_tr_b16 v[54:55], v24 offset:9024
    s_waitcnt vmcnt(23)
    s_waitcnt lgkmcnt(10)
    v_mfma_f32_16x16x32_bf16 v[128:131], v[32:35], v[64:67], 0
    ds_read_b64_tr_b16 v[56:57], v24 offset:96
    ds_read_b64_tr_b16 v[58:59], v24 offset:1888
    s_waitcnt lgkmcnt(10)
    v_mfma_f32_16x16x32_bf16 v[156:159], v[36:39], v[64:67], 0
    ds_read_b64_tr_b16 v[60:61], v24 offset:7264
    ds_read_b64_tr_b16 v[62:63], v24 offset:9056
    s_waitcnt lgkmcnt(10)
    v_mfma_f32_16x16x32_bf16 v[132:135], v[40:43], v[64:67], 0
    ds_read_b64_tr_b16 v[32:33], v24 offset:128
    ds_read_b64_tr_b16 v[34:35], v24 offset:1920
    buffer_load_ushort v184, v19, s[32:35], s62 offen offset:0
    s_waitcnt lgkmcnt(10)
    v_mfma_f32_16x16x32_bf16 v[160:163], v[44:47], v[64:67], 0
    ds_read_b64_tr_b16 v[36:37], v24 offset:7296
    ds_read_b64_tr_b16 v[38:39], v24 offset:9088
    s_waitcnt lgkmcnt(10)
    v_mfma_f32_16x16x32_bf16 v[136:139], v[48:51], v[64:67], 0
    ds_read_b64_tr_b16 v[40:41], v24 offset:160
    ds_read_b64_tr_b16 v[42:43], v24 offset:1952
    s_waitcnt lgkmcnt(10)
    v_mfma_f32_16x16x32_bf16 v[164:167], v[52:55], v[64:67], 0
    ds_read_b64_tr_b16 v[44:45], v24 offset:7328
    ds_read_b64_tr_b16 v[46:47], v24 offset:9120
    buffer_load_ushort v185, v19, s[32:35], s62 offen offset:1024
    s_waitcnt lgkmcnt(10)
    v_mfma_f32_16x16x32_bf16 v[140:143], v[56:59], v[64:67], 0
    ds_read_b64_tr_b16 v[48:49], v24 offset:192
    ds_read_b64_tr_b16 v[50:51], v24 offset:1984
    s_waitcnt lgkmcnt(10)
    v_mfma_f32_16x16x32_bf16 v[168:171], v[60:63], v[64:67], 0
    ds_read_b64_tr_b16 v[52:53], v24 offset:7360
    ds_read_b64_tr_b16 v[54:55], v24 offset:9152
    s_waitcnt lgkmcnt(10)
    v_mfma_f32_16x16x32_bf16 v[144:147], v[32:35], v[64:67], 0
    ds_read_b64_tr_b16 v[56:57], v24 offset:14336
    ds_read_b64_tr_b16 v[58:59], v24 offset:16128
    buffer_load_ushort v186, v19, s[32:35], s62 offen offset:2048
    s_waitcnt lgkmcnt(10)
    v_mfma_f32_16x16x32_bf16 v[172:175], v[36:39], v[64:67], 0
    ds_read_b64_tr_b16 v[60:61], v24 offset:21504
    ds_read_b64_tr_b16 v[62:63], v24 offset:23296
    s_waitcnt lgkmcnt(10)
    v_mfma_f32_16x16x32_bf16 v[148:151], v[40:43], v[64:67], 0
    ds_read_b64_tr_b16 v[32:33], v24 offset:14368
    ds_read_b64_tr_b16 v[34:35], v24 offset:16160
    s_waitcnt lgkmcnt(10)
    v_mfma_f32_16x16x32_bf16 v[176:179], v[44:47], v[64:67], 0
    ds_read_b64_tr_b16 v[36:37], v24 offset:21536
    ds_read_b64_tr_b16 v[38:39], v24 offset:23328
    buffer_load_ushort v187, v19, s[32:35], s62 offen offset:3072
    s_waitcnt lgkmcnt(10)
    v_mfma_f32_16x16x32_bf16 v[152:155], v[48:51], v[64:67], 0
    ds_read_b64_tr_b16 v[40:41], v24 offset:14400
    ds_read_b64_tr_b16 v[42:43], v24 offset:16192
    s_waitcnt lgkmcnt(10)
    v_mfma_f32_16x16x32_bf16 v[180:183], v[52:55], v[64:67], 0
    ds_read_b64_tr_b16 v[44:45], v24 offset:21568
    ds_read_b64_tr_b16 v[46:47], v24 offset:23360
    s_waitcnt vmcnt(26)
    s_waitcnt lgkmcnt(10)
    v_mfma_f32_16x16x32_bf16 v[128:131], v[56:59], v[68:71], v[128:131]
    ds_read_b64_tr_b16 v[48:49], v24 offset:14432
    ds_read_b64_tr_b16 v[50:51], v24 offset:16224
    buffer_load_ushort v188, v19, s[32:35], s63 offen offset:0
    s_waitcnt lgkmcnt(10)
    v_mfma_f32_16x16x32_bf16 v[156:159], v[60:63], v[68:71], v[156:159]
    ds_read_b64_tr_b16 v[52:53], v24 offset:21600
    ds_read_b64_tr_b16 v[54:55], v24 offset:23392
    s_waitcnt lgkmcnt(10)
    v_mfma_f32_16x16x32_bf16 v[132:135], v[32:35], v[68:71], v[132:135]
    ds_read_b64_tr_b16 v[56:57], v24 offset:14464
    ds_read_b64_tr_b16 v[58:59], v24 offset:16256
    s_waitcnt lgkmcnt(10)
    v_mfma_f32_16x16x32_bf16 v[160:163], v[36:39], v[68:71], v[160:163]
    ds_read_b64_tr_b16 v[60:61], v24 offset:21632
    ds_read_b64_tr_b16 v[62:63], v24 offset:23424
    buffer_load_ushort v189, v19, s[32:35], s63 offen offset:1024
    s_waitcnt lgkmcnt(10)
    v_mfma_f32_16x16x32_bf16 v[136:139], v[40:43], v[68:71], v[136:139]
    ds_read_b64_tr_b16 v[32:33], v24 offset:14496
    ds_read_b64_tr_b16 v[34:35], v24 offset:16288
    s_waitcnt lgkmcnt(10)
    v_mfma_f32_16x16x32_bf16 v[164:167], v[44:47], v[68:71], v[164:167]
    ds_read_b64_tr_b16 v[36:37], v24 offset:21664
    ds_read_b64_tr_b16 v[38:39], v24 offset:23456
    s_waitcnt lgkmcnt(10)
    v_mfma_f32_16x16x32_bf16 v[140:143], v[48:51], v[68:71], v[140:143]
    ds_read_b64_tr_b16 v[40:41], v24 offset:14528
    ds_read_b64_tr_b16 v[42:43], v24 offset:16320
    buffer_load_ushort v190, v19, s[32:35], s63 offen offset:2048
    s_waitcnt lgkmcnt(10)
    v_mfma_f32_16x16x32_bf16 v[168:171], v[52:55], v[68:71], v[168:171]
    ds_read_b64_tr_b16 v[44:45], v24 offset:21696
    ds_read_b64_tr_b16 v[46:47], v24 offset:23488
    s_waitcnt lgkmcnt(10)
    v_mfma_f32_16x16x32_bf16 v[144:147], v[56:59], v[68:71], v[144:147]
    ds_read_b64_tr_b16 v[48:49], v25 offset:0
    ds_read_b64_tr_b16 v[50:51], v25 offset:1792
    s_waitcnt lgkmcnt(10)
    v_mfma_f32_16x16x32_bf16 v[172:175], v[60:63], v[68:71], v[172:175]
    ds_read_b64_tr_b16 v[52:53], v25 offset:7168
    ds_read_b64_tr_b16 v[54:55], v25 offset:8960
    buffer_load_ushort v191, v19, s[32:35], s63 offen offset:3072
    s_waitcnt lgkmcnt(10)
    v_mfma_f32_16x16x32_bf16 v[148:151], v[32:35], v[68:71], v[148:151]
    ds_read_b64_tr_b16 v[56:57], v25 offset:32
    ds_read_b64_tr_b16 v[58:59], v25 offset:1824
    s_waitcnt lgkmcnt(10)
    v_mfma_f32_16x16x32_bf16 v[176:179], v[36:39], v[68:71], v[176:179]
    ds_read_b64_tr_b16 v[60:61], v25 offset:7200
    ds_read_b64_tr_b16 v[62:63], v25 offset:8992
    s_waitcnt lgkmcnt(10)
    v_mfma_f32_16x16x32_bf16 v[152:155], v[40:43], v[68:71], v[152:155]
    ds_read_b64_tr_b16 v[32:33], v25 offset:64
    ds_read_b64_tr_b16 v[34:35], v25 offset:1856
    s_waitcnt lgkmcnt(10)
    v_mfma_f32_16x16x32_bf16 v[180:183], v[44:47], v[68:71], v[180:183]
    ds_read_b64_tr_b16 v[36:37], v25 offset:7232
    ds_read_b64_tr_b16 v[38:39], v25 offset:9024
    s_waitcnt vmcnt(16)
    s_barrier
    s_add_u32 s75, s6, 917504
    s_add_u32 m0, s7, 0
    s_mov_b32 exec_hi, 0x00ffffff
    buffer_load_dwordx4 v18, s[16:19], s75 offen lds
    s_mov_b32 exec_hi, -1
    s_add_u32 s75, s6, 917504
    s_add_u32 m0, s7, 7168
    s_mov_b32 exec_hi, 0x00ffffff
    buffer_load_dwordx4 v18, s[20:23], s75 offen lds
    s_mov_b32 exec_hi, -1
    s_add_u32 s75, s6, 1032192
    s_add_u32 m0, s7, 14336
    s_mov_b32 exec_hi, 0x00ffffff
    buffer_load_dwordx4 v18, s[16:19], s75 offen lds
    s_mov_b32 exec_hi, -1
    s_add_u32 s75, s6, 1032192
    s_add_u32 m0, s7, 21504
    s_mov_b32 exec_hi, 0x00ffffff
    buffer_load_dwordx4 v18, s[20:23], s75 offen lds
    s_mov_b32 exec_hi, -1
    s_waitcnt vmcnt(33)
    s_waitcnt lgkmcnt(10)
    v_mfma_f32_16x16x32_bf16 v[128:131], v[48:51], v[72:75], v[128:131]
    ds_read_b64_tr_b16 v[40:41], v25 offset:96
    ds_read_b64_tr_b16 v[42:43], v25 offset:1888
    s_waitcnt lgkmcnt(10)
    v_mfma_f32_16x16x32_bf16 v[156:159], v[52:55], v[72:75], v[156:159]
    ds_read_b64_tr_b16 v[44:45], v25 offset:7264
    ds_read_b64_tr_b16 v[46:47], v25 offset:9056
    s_waitcnt lgkmcnt(10)
    v_mfma_f32_16x16x32_bf16 v[132:135], v[56:59], v[72:75], v[132:135]
    ds_read_b64_tr_b16 v[48:49], v25 offset:128
    ds_read_b64_tr_b16 v[50:51], v25 offset:1920
    s_waitcnt lgkmcnt(10)
    v_mfma_f32_16x16x32_bf16 v[160:163], v[60:63], v[72:75], v[160:163]
    ds_read_b64_tr_b16 v[52:53], v25 offset:7296
    ds_read_b64_tr_b16 v[54:55], v25 offset:9088
    s_waitcnt lgkmcnt(10)
    v_mfma_f32_16x16x32_bf16 v[136:139], v[32:35], v[72:75], v[136:139]
    ds_read_b64_tr_b16 v[56:57], v25 offset:160
    ds_read_b64_tr_b16 v[58:59], v25 offset:1952
    s_waitcnt lgkmcnt(10)
    v_mfma_f32_16x16x32_bf16 v[164:167], v[36:39], v[72:75], v[164:167]
    ds_read_b64_tr_b16 v[60:61], v25 offset:7328
    ds_read_b64_tr_b16 v[62:63], v25 offset:9120
    s_waitcnt lgkmcnt(10)
    v_mfma_f32_16x16x32_bf16 v[140:143], v[40:43], v[72:75], v[140:143]
    ds_read_b64_tr_b16 v[32:33], v25 offset:192
    ds_read_b64_tr_b16 v[34:35], v25 offset:1984
    s_waitcnt lgkmcnt(10)
    v_mfma_f32_16x16x32_bf16 v[168:171], v[44:47], v[72:75], v[168:171]
    ds_read_b64_tr_b16 v[36:37], v25 offset:7360
    ds_read_b64_tr_b16 v[38:39], v25 offset:9152
    s_waitcnt lgkmcnt(10)
    v_mfma_f32_16x16x32_bf16 v[144:147], v[48:51], v[72:75], v[144:147]
    ds_read_b64_tr_b16 v[40:41], v25 offset:14336
    ds_read_b64_tr_b16 v[42:43], v25 offset:16128
    s_waitcnt lgkmcnt(10)
    v_mfma_f32_16x16x32_bf16 v[172:175], v[52:55], v[72:75], v[172:175]
    ds_read_b64_tr_b16 v[44:45], v25 offset:21504
    ds_read_b64_tr_b16 v[46:47], v25 offset:23296
    s_waitcnt lgkmcnt(10)
    v_mfma_f32_16x16x32_bf16 v[148:151], v[56:59], v[72:75], v[148:151]
    ds_read_b64_tr_b16 v[48:49], v25 offset:14368
    ds_read_b64_tr_b16 v[50:51], v25 offset:16160
    s_waitcnt lgkmcnt(10)
    v_mfma_f32_16x16x32_bf16 v[176:179], v[60:63], v[72:75], v[176:179]
    ds_read_b64_tr_b16 v[52:53], v25 offset:21536
    ds_read_b64_tr_b16 v[54:55], v25 offset:23328
    s_waitcnt lgkmcnt(10)
    v_mfma_f32_16x16x32_bf16 v[152:155], v[32:35], v[72:75], v[152:155]
    ds_read_b64_tr_b16 v[56:57], v25 offset:14400
    ds_read_b64_tr_b16 v[58:59], v25 offset:16192
    s_waitcnt lgkmcnt(10)
    v_mfma_f32_16x16x32_bf16 v[180:183], v[36:39], v[72:75], v[180:183]
    ds_read_b64_tr_b16 v[60:61], v25 offset:21568
    ds_read_b64_tr_b16 v[62:63], v25 offset:23360
    s_waitcnt vmcnt(32)
    s_waitcnt lgkmcnt(10)
    v_mfma_f32_16x16x32_bf16 v[128:131], v[40:43], v[76:79], v[128:131]
    ds_read_b64_tr_b16 v[32:33], v25 offset:14432
    ds_read_b64_tr_b16 v[34:35], v25 offset:16224
    s_waitcnt lgkmcnt(10)
    v_mfma_f32_16x16x32_bf16 v[156:159], v[44:47], v[76:79], v[156:159]
    ds_read_b64_tr_b16 v[36:37], v25 offset:21600
    ds_read_b64_tr_b16 v[38:39], v25 offset:23392
    s_waitcnt lgkmcnt(10)
    v_mfma_f32_16x16x32_bf16 v[132:135], v[48:51], v[76:79], v[132:135]
    ds_read_b64_tr_b16 v[40:41], v25 offset:14464
    ds_read_b64_tr_b16 v[42:43], v25 offset:16256
    s_waitcnt lgkmcnt(10)
    v_mfma_f32_16x16x32_bf16 v[160:163], v[52:55], v[76:79], v[160:163]
    ds_read_b64_tr_b16 v[44:45], v25 offset:21632
    ds_read_b64_tr_b16 v[46:47], v25 offset:23424
    s_waitcnt lgkmcnt(10)
    v_mfma_f32_16x16x32_bf16 v[136:139], v[56:59], v[76:79], v[136:139]
    ds_read_b64_tr_b16 v[48:49], v25 offset:14496
    ds_read_b64_tr_b16 v[50:51], v25 offset:16288
    s_waitcnt lgkmcnt(10)
    v_mfma_f32_16x16x32_bf16 v[164:167], v[60:63], v[76:79], v[164:167]
    ds_read_b64_tr_b16 v[52:53], v25 offset:21664
    ds_read_b64_tr_b16 v[54:55], v25 offset:23456
    s_waitcnt lgkmcnt(10)
    v_mfma_f32_16x16x32_bf16 v[140:143], v[32:35], v[76:79], v[140:143]
    ds_read_b64_tr_b16 v[56:57], v25 offset:14528
    ds_read_b64_tr_b16 v[58:59], v25 offset:16320
    s_waitcnt lgkmcnt(10)
    v_mfma_f32_16x16x32_bf16 v[168:171], v[36:39], v[76:79], v[168:171]
    ds_read_b64_tr_b16 v[60:61], v25 offset:21696
    ds_read_b64_tr_b16 v[62:63], v25 offset:23488
    s_waitcnt lgkmcnt(10)
    v_mfma_f32_16x16x32_bf16 v[144:147], v[40:43], v[76:79], v[144:147]
    ds_read_b64_tr_b16 v[32:33], v26 offset:0
    ds_read_b64_tr_b16 v[34:35], v26 offset:1792
    s_waitcnt lgkmcnt(10)
    v_mfma_f32_16x16x32_bf16 v[172:175], v[44:47], v[76:79], v[172:175]
    ds_read_b64_tr_b16 v[36:37], v26 offset:7168
    ds_read_b64_tr_b16 v[38:39], v26 offset:8960
    s_waitcnt lgkmcnt(10)
    v_mfma_f32_16x16x32_bf16 v[148:151], v[48:51], v[76:79], v[148:151]
    ds_read_b64_tr_b16 v[40:41], v26 offset:32
    ds_read_b64_tr_b16 v[42:43], v26 offset:1824
    s_waitcnt lgkmcnt(10)
    v_mfma_f32_16x16x32_bf16 v[176:179], v[52:55], v[76:79], v[176:179]
    ds_read_b64_tr_b16 v[44:45], v26 offset:7200
    ds_read_b64_tr_b16 v[46:47], v26 offset:8992
    s_waitcnt lgkmcnt(10)
    v_mfma_f32_16x16x32_bf16 v[152:155], v[56:59], v[76:79], v[152:155]
    ds_read_b64_tr_b16 v[48:49], v26 offset:64
    ds_read_b64_tr_b16 v[50:51], v26 offset:1856
    s_waitcnt lgkmcnt(10)
    v_mfma_f32_16x16x32_bf16 v[180:183], v[60:63], v[76:79], v[180:183]
    ds_read_b64_tr_b16 v[52:53], v26 offset:7232
    ds_read_b64_tr_b16 v[54:55], v26 offset:9024
    s_waitcnt vmcnt(4)
    v_lshl_or_b32 v12, v185, 16, v184
    v_lshl_or_b32 v13, v187, 16, v186
    v_lshl_or_b32 v14, v189, 16, v188
    v_lshl_or_b32 v15, v191, 16, v190
    s_lshl_b32 s66, s66, 10
    s_add_u32 s66, s66, 8388608
    buffer_store_dwordx4 v[12:15], v5, s[12:15], s66 offen sc1
    s_waitcnt vmcnt(17)
    s_barrier
    s_add_u32 s75, s6, 1146880
    s_add_u32 m0, s7, 28672
    s_mov_b32 exec_hi, 0x00ffffff
    buffer_load_dwordx4 v18, s[16:19], s75 offen lds
    s_mov_b32 exec_hi, -1
    s_add_u32 s75, s6, 1146880
    s_add_u32 m0, s7, 35840
    s_mov_b32 exec_hi, 0x00ffffff
    buffer_load_dwordx4 v18, s[20:23], s75 offen lds
    s_mov_b32 exec_hi, -1
    s_add_u32 s75, s6, 1261568
    s_add_u32 m0, s7, 43008
    s_mov_b32 exec_hi, 0x00ffffff
    buffer_load_dwordx4 v18, s[16:19], s75 offen lds
    s_mov_b32 exec_hi, -1
    s_add_u32 s75, s6, 1261568
    s_add_u32 m0, s7, 50176
    s_mov_b32 exec_hi, 0x00ffffff
    buffer_load_dwordx4 v18, s[20:23], s75 offen lds
    s_mov_b32 exec_hi, -1
    s_waitcnt vmcnt(36)
    s_waitcnt lgkmcnt(10)
    v_mfma_f32_16x16x32_bf16 v[128:131], v[32:35], v[80:83], v[128:131]
    ds_read_b64_tr_b16 v[56:57], v26 offset:96
    ds_read_b64_tr_b16 v[58:59], v26 offset:1888
    s_waitcnt lgkmcnt(10)
    v_mfma_f32_16x16x32_bf16 v[156:159], v[36:39], v[80:83], v[156:159]
    ds_read_b64_tr_b16 v[60:61], v26 offset:7264
    ds_read_b64_tr_b16 v[62:63], v26 offset:9056
    s_waitcnt lgkmcnt(10)
    v_mfma_f32_16x16x32_bf16 v[132:135], v[40:43], v[80:83], v[132:135]
    ds_read_b64_tr_b16 v[32:33], v26 offset:128
    ds_read_b64_tr_b16 v[34:35], v26 offset:1920
    s_waitcnt lgkmcnt(10)
    v_mfma_f32_16x16x32_bf16 v[160:163], v[44:47], v[80:83], v[160:163]
    ds_read_b64_tr_b16 v[36:37], v26 offset:7296
    ds_read_b64_tr_b16 v[38:39], v26 offset:9088
    s_waitcnt lgkmcnt(10)
    v_mfma_f32_16x16x32_bf16 v[136:139], v[48:51], v[80:83], v[136:139]
    ds_read_b64_tr_b16 v[40:41], v26 offset:160
    ds_read_b64_tr_b16 v[42:43], v26 offset:1952
    s_waitcnt lgkmcnt(10)
    v_mfma_f32_16x16x32_bf16 v[164:167], v[52:55], v[80:83], v[164:167]
    ds_read_b64_tr_b16 v[44:45], v26 offset:7328
    ds_read_b64_tr_b16 v[46:47], v26 offset:9120
    s_waitcnt lgkmcnt(10)
    v_mfma_f32_16x16x32_bf16 v[140:143], v[56:59], v[80:83], v[140:143]
    ds_read_b64_tr_b16 v[48:49], v26 offset:192
    ds_read_b64_tr_b16 v[50:51], v26 offset:1984
    s_waitcnt lgkmcnt(10)
    v_mfma_f32_16x16x32_bf16 v[168:171], v[60:63], v[80:83], v[168:171]
    ds_read_b64_tr_b16 v[52:53], v26 offset:7360
    ds_read_b64_tr_b16 v[54:55], v26 offset:9152
    s_waitcnt lgkmcnt(10)
    v_mfma_f32_16x16x32_bf16 v[144:147], v[32:35], v[80:83], v[144:147]
    ds_read_b64_tr_b16 v[56:57], v26 offset:14336
    ds_read_b64_tr_b16 v[58:59], v26 offset:16128
    s_waitcnt lgkmcnt(10)
    v_mfma_f32_16x16x32_bf16 v[172:175], v[36:39], v[80:83], v[172:175]
    ds_read_b64_tr_b16 v[60:61], v26 offset:21504
    ds_read_b64_tr_b16 v[62:63], v26 offset:23296
    s_waitcnt lgkmcnt(10)
    v_mfma_f32_16x16x32_bf16 v[148:151], v[40:43], v[80:83], v[148:151]
    ds_read_b64_tr_b16 v[32:33], v26 offset:14368
    ds_read_b64_tr_b16 v[34:35], v26 offset:16160
    s_waitcnt lgkmcnt(10)
    v_mfma_f32_16x16x32_bf16 v[176:179], v[44:47], v[80:83], v[176:179]
    ds_read_b64_tr_b16 v[36:37], v26 offset:21536
    ds_read_b64_tr_b16 v[38:39], v26 offset:23328
    s_waitcnt lgkmcnt(10)
    v_mfma_f32_16x16x32_bf16 v[152:155], v[48:51], v[80:83], v[152:155]
    ds_read_b64_tr_b16 v[40:41], v26 offset:14400
    ds_read_b64_tr_b16 v[42:43], v26 offset:16192
    s_waitcnt lgkmcnt(10)
    v_mfma_f32_16x16x32_bf16 v[180:183], v[52:55], v[80:83], v[180:183]
    ds_read_b64_tr_b16 v[44:45], v26 offset:21568
    ds_read_b64_tr_b16 v[46:47], v26 offset:23360
    s_waitcnt vmcnt(35)
    s_waitcnt lgkmcnt(10)
    v_mfma_f32_16x16x32_bf16 v[128:131], v[56:59], v[84:87], v[128:131]
    ds_read_b64_tr_b16 v[48:49], v26 offset:14432
    ds_read_b64_tr_b16 v[50:51], v26 offset:16224
    s_waitcnt lgkmcnt(10)
    v_mfma_f32_16x16x32_bf16 v[156:159], v[60:63], v[84:87], v[156:159]
    ds_read_b64_tr_b16 v[52:53], v26 offset:21600
    ds_read_b64_tr_b16 v[54:55], v26 offset:23392
    s_waitcnt lgkmcnt(10)
    v_mfma_f32_16x16x32_bf16 v[132:135], v[32:35], v[84:87], v[132:135]
    ds_read_b64_tr_b16 v[56:57], v26 offset:14464
    ds_read_b64_tr_b16 v[58:59], v26 offset:16256
    s_waitcnt lgkmcnt(10)
    v_mfma_f32_16x16x32_bf16 v[160:163], v[36:39], v[84:87], v[160:163]
    ds_read_b64_tr_b16 v[60:61], v26 offset:21632
    ds_read_b64_tr_b16 v[62:63], v26 offset:23424
    s_waitcnt lgkmcnt(10)
    v_mfma_f32_16x16x32_bf16 v[136:139], v[40:43], v[84:87], v[136:139]
    ds_read_b64_tr_b16 v[32:33], v26 offset:14496
    ds_read_b64_tr_b16 v[34:35], v26 offset:16288
    s_waitcnt lgkmcnt(10)
    v_mfma_f32_16x16x32_bf16 v[164:167], v[44:47], v[84:87], v[164:167]
    ds_read_b64_tr_b16 v[36:37], v26 offset:21664
    ds_read_b64_tr_b16 v[38:39], v26 offset:23456
    s_waitcnt lgkmcnt(10)
    v_mfma_f32_16x16x32_bf16 v[140:143], v[48:51], v[84:87], v[140:143]
    ds_read_b64_tr_b16 v[40:41], v26 offset:14528
    ds_read_b64_tr_b16 v[42:43], v26 offset:16320
    s_waitcnt lgkmcnt(10)
    v_mfma_f32_16x16x32_bf16 v[168:171], v[52:55], v[84:87], v[168:171]
    ds_read_b64_tr_b16 v[44:45], v26 offset:21696
    ds_read_b64_tr_b16 v[46:47], v26 offset:23488
    s_waitcnt lgkmcnt(10)
    v_mfma_f32_16x16x32_bf16 v[144:147], v[56:59], v[84:87], v[144:147]
    ds_read_b64_tr_b16 v[48:49], v27 offset:0
    ds_read_b64_tr_b16 v[50:51], v27 offset:1792
    s_waitcnt lgkmcnt(10)
    v_mfma_f32_16x16x32_bf16 v[172:175], v[60:63], v[84:87], v[172:175]
    ds_read_b64_tr_b16 v[52:53], v27 offset:7168
    ds_read_b64_tr_b16 v[54:55], v27 offset:8960
    s_waitcnt lgkmcnt(10)
    v_mfma_f32_16x16x32_bf16 v[148:151], v[32:35], v[84:87], v[148:151]
    ds_read_b64_tr_b16 v[56:57], v27 offset:32
    ds_read_b64_tr_b16 v[58:59], v27 offset:1824
    s_waitcnt lgkmcnt(10)
    v_mfma_f32_16x16x32_bf16 v[176:179], v[36:39], v[84:87], v[176:179]
    ds_read_b64_tr_b16 v[60:61], v27 offset:7200
    ds_read_b64_tr_b16 v[62:63], v27 offset:8992
    s_waitcnt lgkmcnt(10)
    v_mfma_f32_16x16x32_bf16 v[152:155], v[40:43], v[84:87], v[152:155]
    ds_read_b64_tr_b16 v[32:33], v27 offset:64
    ds_read_b64_tr_b16 v[34:35], v27 offset:1856
    s_waitcnt lgkmcnt(10)
    v_mfma_f32_16x16x32_bf16 v[180:183], v[44:47], v[84:87], v[180:183]
    ds_read_b64_tr_b16 v[36:37], v27 offset:7232
    ds_read_b64_tr_b16 v[38:39], v27 offset:9024
    s_waitcnt vmcnt(5)
    s_barrier
    s_add_u32 s75, s6, 1376256
    s_add_u32 m0, s7, 57344
    s_mov_b32 exec_hi, 0x00ffffff
    buffer_load_dwordx4 v18, s[16:19], s75 offen lds
    s_mov_b32 exec_hi, -1
    s_add_u32 s75, s6, 1376256
    s_add_u32 m0, s7, 64512
    s_mov_b32 exec_hi, 0x00ffffff
    buffer_load_dwordx4 v18, s[20:23], s75 offen lds
    s_mov_b32 exec_hi, -1
    s_add_u32 s75, s6, 1490944
    s_add_u32 m0, s7, 71680
    s_mov_b32 exec_hi, 0x00ffffff
    buffer_load_dwordx4 v18, s[16:19], s75 offen lds
    s_mov_b32 exec_hi, -1
    s_add_u32 s75, s6, 1490944
    s_add_u32 m0, s7, 78848
    s_mov_b32 exec_hi, 0x00ffffff
    buffer_load_dwordx4 v18, s[20:23], s75 offen lds
    s_mov_b32 exec_hi, -1
    s_waitcnt vmcnt(38)
    s_waitcnt lgkmcnt(10)
    v_mfma_f32_16x16x32_bf16 v[128:131], v[48:51], v[88:91], v[128:131]
    ds_read_b64_tr_b16 v[40:41], v27 offset:96
    ds_read_b64_tr_b16 v[42:43], v27 offset:1888
    s_waitcnt lgkmcnt(10)
    v_mfma_f32_16x16x32_bf16 v[156:159], v[52:55], v[88:91], v[156:159]
    ds_read_b64_tr_b16 v[44:45], v27 offset:7264
    ds_read_b64_tr_b16 v[46:47], v27 offset:9056
    s_waitcnt lgkmcnt(10)
    v_mfma_f32_16x16x32_bf16 v[132:135], v[56:59], v[88:91], v[132:135]
    ds_read_b64_tr_b16 v[48:49], v27 offset:128
    ds_read_b64_tr_b16 v[50:51], v27 offset:1920
    s_waitcnt lgkmcnt(10)
    v_mfma_f32_16x16x32_bf16 v[160:163], v[60:63], v[88:91], v[160:163]
    ds_read_b64_tr_b16 v[52:53], v27 offset:7296
    ds_read_b64_tr_b16 v[54:55], v27 offset:9088
    s_waitcnt lgkmcnt(10)
    v_mfma_f32_16x16x32_bf16 v[136:139], v[32:35], v[88:91], v[136:139]
    ds_read_b64_tr_b16 v[56:57], v27 offset:160
    ds_read_b64_tr_b16 v[58:59], v27 offset:1952
    s_waitcnt lgkmcnt(10)
    v_mfma_f32_16x16x32_bf16 v[164:167], v[36:39], v[88:91], v[164:167]
    ds_read_b64_tr_b16 v[60:61], v27 offset:7328
    ds_read_b64_tr_b16 v[62:63], v27 offset:9120
    s_waitcnt lgkmcnt(10)
    v_mfma_f32_16x16x32_bf16 v[140:143], v[40:43], v[88:91], v[140:143]
    ds_read_b64_tr_b16 v[32:33], v27 offset:192
    ds_read_b64_tr_b16 v[34:35], v27 offset:1984
    s_waitcnt lgkmcnt(10)
    v_mfma_f32_16x16x32_bf16 v[168:171], v[44:47], v[88:91], v[168:171]
    ds_read_b64_tr_b16 v[36:37], v27 offset:7360
    ds_read_b64_tr_b16 v[38:39], v27 offset:9152
    s_waitcnt lgkmcnt(10)
    v_mfma_f32_16x16x32_bf16 v[144:147], v[48:51], v[88:91], v[144:147]
    ds_read_b64_tr_b16 v[40:41], v27 offset:14336
    ds_read_b64_tr_b16 v[42:43], v27 offset:16128
    s_waitcnt lgkmcnt(10)
    v_mfma_f32_16x16x32_bf16 v[172:175], v[52:55], v[88:91], v[172:175]
    ds_read_b64_tr_b16 v[44:45], v27 offset:21504
    ds_read_b64_tr_b16 v[46:47], v27 offset:23296
    s_waitcnt lgkmcnt(10)
    v_mfma_f32_16x16x32_bf16 v[148:151], v[56:59], v[88:91], v[148:151]
    ds_read_b64_tr_b16 v[48:49], v27 offset:14368
    ds_read_b64_tr_b16 v[50:51], v27 offset:16160
    s_waitcnt lgkmcnt(10)
    v_mfma_f32_16x16x32_bf16 v[176:179], v[60:63], v[88:91], v[176:179]
    ds_read_b64_tr_b16 v[52:53], v27 offset:21536
    ds_read_b64_tr_b16 v[54:55], v27 offset:23328
    s_waitcnt lgkmcnt(10)
    v_mfma_f32_16x16x32_bf16 v[152:155], v[32:35], v[88:91], v[152:155]
    ds_read_b64_tr_b16 v[56:57], v27 offset:14400
    ds_read_b64_tr_b16 v[58:59], v27 offset:16192
    s_waitcnt lgkmcnt(10)
    v_mfma_f32_16x16x32_bf16 v[180:183], v[36:39], v[88:91], v[180:183]
    ds_read_b64_tr_b16 v[60:61], v27 offset:21568
    ds_read_b64_tr_b16 v[62:63], v27 offset:23360
    s_waitcnt vmcnt(37)
    s_waitcnt lgkmcnt(10)
    v_mfma_f32_16x16x32_bf16 v[128:131], v[40:43], v[92:95], v[128:131]
    ds_read_b64_tr_b16 v[32:33], v27 offset:14432
    ds_read_b64_tr_b16 v[34:35], v27 offset:16224
    s_waitcnt lgkmcnt(10)
    v_mfma_f32_16x16x32_bf16 v[156:159], v[44:47], v[92:95], v[156:159]
    ds_read_b64_tr_b16 v[36:37], v27 offset:21600
    ds_read_b64_tr_b16 v[38:39], v27 offset:23392
    s_waitcnt lgkmcnt(10)
    v_mfma_f32_16x16x32_bf16 v[132:135], v[48:51], v[92:95], v[132:135]
    ds_read_b64_tr_b16 v[40:41], v27 offset:14464
    ds_read_b64_tr_b16 v[42:43], v27 offset:16256
    s_waitcnt lgkmcnt(10)
    v_mfma_f32_16x16x32_bf16 v[160:163], v[52:55], v[92:95], v[160:163]
    ds_read_b64_tr_b16 v[44:45], v27 offset:21632
    ds_read_b64_tr_b16 v[46:47], v27 offset:23424
    s_waitcnt lgkmcnt(10)
    v_mfma_f32_16x16x32_bf16 v[136:139], v[56:59], v[92:95], v[136:139]
    ds_read_b64_tr_b16 v[48:49], v27 offset:14496
    ds_read_b64_tr_b16 v[50:51], v27 offset:16288
    s_waitcnt lgkmcnt(10)
    v_mfma_f32_16x16x32_bf16 v[164:167], v[60:63], v[92:95], v[164:167]
    ds_read_b64_tr_b16 v[52:53], v27 offset:21664
    ds_read_b64_tr_b16 v[54:55], v27 offset:23456
    s_waitcnt lgkmcnt(10)
    v_mfma_f32_16x16x32_bf16 v[140:143], v[32:35], v[92:95], v[140:143]
    ds_read_b64_tr_b16 v[56:57], v27 offset:14528
    ds_read_b64_tr_b16 v[58:59], v27 offset:16320
    s_waitcnt lgkmcnt(10)
    v_mfma_f32_16x16x32_bf16 v[168:171], v[36:39], v[92:95], v[168:171]
    ds_read_b64_tr_b16 v[60:61], v27 offset:21696
    ds_read_b64_tr_b16 v[62:63], v27 offset:23488
    s_waitcnt lgkmcnt(10)
    v_mfma_f32_16x16x32_bf16 v[144:147], v[40:43], v[92:95], v[144:147]
    ds_read_b64_tr_b16 v[32:33], v24 offset:0
    ds_read_b64_tr_b16 v[34:35], v24 offset:1792
    s_waitcnt lgkmcnt(10)
    v_mfma_f32_16x16x32_bf16 v[172:175], v[44:47], v[92:95], v[172:175]
    ds_read_b64_tr_b16 v[36:37], v24 offset:7168
    ds_read_b64_tr_b16 v[38:39], v24 offset:8960
    s_waitcnt lgkmcnt(10)
    v_mfma_f32_16x16x32_bf16 v[148:151], v[48:51], v[92:95], v[148:151]
    ds_read_b64_tr_b16 v[40:41], v24 offset:32
    ds_read_b64_tr_b16 v[42:43], v24 offset:1824
    s_waitcnt lgkmcnt(10)
    v_mfma_f32_16x16x32_bf16 v[176:179], v[52:55], v[92:95], v[176:179]
    ds_read_b64_tr_b16 v[44:45], v24 offset:7200
    ds_read_b64_tr_b16 v[46:47], v24 offset:8992
    s_waitcnt lgkmcnt(10)
    v_mfma_f32_16x16x32_bf16 v[152:155], v[56:59], v[92:95], v[152:155]
    ds_read_b64_tr_b16 v[48:49], v24 offset:64
    ds_read_b64_tr_b16 v[50:51], v24 offset:1856
    s_waitcnt lgkmcnt(10)
    v_mfma_f32_16x16x32_bf16 v[180:183], v[60:63], v[92:95], v[180:183]
    ds_read_b64_tr_b16 v[52:53], v24 offset:7232
    ds_read_b64_tr_b16 v[54:55], v24 offset:9024
    s_waitcnt vmcnt(4)
    s_barrier
    s_cmp_lg_u32 s3, 0
    s_cbranch_scc1 LsigW_skip
    s_lshr_b32 s76, s2, 4
    s_lshl_b32 s76, s76, 8
    s_add_u32 s76, s76, 10240
    v_mov_b32 v10, s76
    v_mov_b32 v11, 1
    s_mov_b64 exec, 1
    buffer_atomic_add v11, v10, s[12:15], 0 offen sc1
    s_mov_b64 exec, -1
LsigW_skip:
    s_add_u32 s75, s6, 1605632
    s_add_u32 m0, s7, 86016
    s_mov_b32 exec_hi, 0x00ffffff
    buffer_load_dwordx4 v18, s[16:19], s75 offen lds
    s_mov_b32 exec_hi, -1
    s_add_u32 s75, s6, 1605632
    s_add_u32 m0, s7, 93184
    s_mov_b32 exec_hi, 0x00ffffff
    buffer_load_dwordx4 v18, s[20:23], s75 offen lds
    s_mov_b32 exec_hi, -1
    s_add_u32 s75, s6, 1720320
    s_add_u32 m0, s7, 100352
    s_mov_b32 exec_hi, 0x00ffffff
    buffer_load_dwordx4 v18, s[16:19], s75 offen lds
    s_mov_b32 exec_hi, -1
    s_add_u32 s75, s6, 1720320
    s_add_u32 m0, s7, 107520
    s_mov_b32 exec_hi, 0x00ffffff
    buffer_load_dwordx4 v18, s[20:23], s75 offen lds
    s_mov_b32 exec_hi, -1
    s_waitcnt vmcnt(40)
    s_waitcnt lgkmcnt(10)
    v_mfma_f32_16x16x32_bf16 v[128:131], v[32:35], v[96:99], v[128:131]
    ds_read_b64_tr_b16 v[56:57], v24 offset:96
    ds_read_b64_tr_b16 v[58:59], v24 offset:1888
    s_waitcnt lgkmcnt(10)
    v_mfma_f32_16x16x32_bf16 v[156:159], v[36:39], v[96:99], v[156:159]
    ds_read_b64_tr_b16 v[60:61], v24 offset:7264
    ds_read_b64_tr_b16 v[62:63], v24 offset:9056
    s_waitcnt lgkmcnt(10)
    v_mfma_f32_16x16x32_bf16 v[132:135], v[40:43], v[96:99], v[132:135]
    ds_read_b64_tr_b16 v[32:33], v24 offset:128
    ds_read_b64_tr_b16 v[34:35], v24 offset:1920
    s_waitcnt lgkmcnt(10)
    v_mfma_f32_16x16x32_bf16 v[160:163], v[44:47], v[96:99], v[160:163]
    ds_read_b64_tr_b16 v[36:37], v24 offset:7296
    ds_read_b64_tr_b16 v[38:39], v24 offset:9088
    s_waitcnt lgkmcnt(10)
    v_mfma_f32_16x16x32_bf16 v[136:139], v[48:51], v[96:99], v[136:139]
    ds_read_b64_tr_b16 v[40:41], v24 offset:160
    ds_read_b64_tr_b16 v[42:43], v24 offset:1952
    s_waitcnt lgkmcnt(10)
    v_mfma_f32_16x16x32_bf16 v[164:167], v[52:55], v[96:99], v[164:167]
    ds_read_b64_tr_b16 v[44:45], v24 offset:7328
    ds_read_b64_tr_b16 v[46:47], v24 offset:9120
    s_waitcnt lgkmcnt(10)
    v_mfma_f32_16x16x32_bf16 v[140:143], v[56:59], v[96:99], v[140:143]
    ds_read_b64_tr_b16 v[48:49], v24 offset:192
    ds_read_b64_tr_b16 v[50:51], v24 offset:1984
    s_waitcnt lgkmcnt(10)
    v_mfma_f32_16x16x32_bf16 v[168:171], v[60:63], v[96:99], v[168:171]
    ds_read_b64_tr_b16 v[52:53], v24 offset:7360
    ds_read_b64_tr_b16 v[54:55], v24 offset:9152
    s_waitcnt lgkmcnt(10)
    v_mfma_f32_16x16x32_bf16 v[144:147], v[32:35], v[96:99], v[144:147]
    ds_read_b64_tr_b16 v[56:57], v24 offset:14336
    ds_read_b64_tr_b16 v[58:59], v24 offset:16128
    s_waitcnt lgkmcnt(10)
    v_mfma_f32_16x16x32_bf16 v[172:175], v[36:39], v[96:99], v[172:175]
    ds_read_b64_tr_b16 v[60:61], v24 offset:21504
    ds_read_b64_tr_b16 v[62:63], v24 offset:23296
    s_waitcnt lgkmcnt(10)
    v_mfma_f32_16x16x32_bf16 v[148:151], v[40:43], v[96:99], v[148:151]
    ds_read_b64_tr_b16 v[32:33], v24 offset:14368
    ds_read_b64_tr_b16 v[34:35], v24 offset:16160
    s_waitcnt lgkmcnt(10)
    v_mfma_f32_16x16x32_bf16 v[176:179], v[44:47], v[96:99], v[176:179]
    ds_read_b64_tr_b16 v[36:37], v24 offset:21536
    ds_read_b64_tr_b16 v[38:39], v24 offset:23328
    s_waitcnt lgkmcnt(10)
    v_mfma_f32_16x16x32_bf16 v[152:155], v[48:51], v[96:99], v[152:155]
    ds_read_b64_tr_b16 v[40:41], v24 offset:14400
    ds_read_b64_tr_b16 v[42:43], v24 offset:16192
    s_waitcnt lgkmcnt(10)
    v_mfma_f32_16x16x32_bf16 v[180:183], v[52:55], v[96:99], v[180:183]
    ds_read_b64_tr_b16 v[44:45], v24 offset:21568
    ds_read_b64_tr_b16 v[46:47], v24 offset:23360
    s_waitcnt vmcnt(39)
    s_waitcnt lgkmcnt(10)
    v_mfma_f32_16x16x32_bf16 v[128:131], v[56:59], v[100:103], v[128:131]
    ds_read_b64_tr_b16 v[48:49], v24 offset:14432
    ds_read_b64_tr_b16 v[50:51], v24 offset:16224
    s_waitcnt lgkmcnt(10)
    v_mfma_f32_16x16x32_bf16 v[156:159], v[60:63], v[100:103], v[156:159]
    ds_read_b64_tr_b16 v[52:53], v24 offset:21600
    ds_read_b64_tr_b16 v[54:55], v24 offset:23392
    s_waitcnt lgkmcnt(10)
    v_mfma_f32_16x16x32_bf16 v[132:135], v[32:35], v[100:103], v[132:135]
    ds_read_b64_tr_b16 v[56:57], v24 offset:14464
    ds_read_b64_tr_b16 v[58:59], v24 offset:16256
    s_waitcnt lgkmcnt(10)
    v_mfma_f32_16x16x32_bf16 v[160:163], v[36:39], v[100:103], v[160:163]
    ds_read_b64_tr_b16 v[60:61], v24 offset:21632
    ds_read_b64_tr_b16 v[62:63], v24 offset:23424
    s_waitcnt lgkmcnt(10)
    v_mfma_f32_16x16x32_bf16 v[136:139], v[40:43], v[100:103], v[136:139]
    ds_read_b64_tr_b16 v[32:33], v24 offset:14496
    ds_read_b64_tr_b16 v[34:35], v24 offset:16288
    s_waitcnt lgkmcnt(10)
    v_mfma_f32_16x16x32_bf16 v[164:167], v[44:47], v[100:103], v[164:167]
    ds_read_b64_tr_b16 v[36:37], v24 offset:21664
    ds_read_b64_tr_b16 v[38:39], v24 offset:23456
    s_waitcnt lgkmcnt(10)
    v_mfma_f32_16x16x32_bf16 v[140:143], v[48:51], v[100:103], v[140:143]
    ds_read_b64_tr_b16 v[40:41], v24 offset:14528
    ds_read_b64_tr_b16 v[42:43], v24 offset:16320
    s_waitcnt lgkmcnt(10)
    v_mfma_f32_16x16x32_bf16 v[168:171], v[52:55], v[100:103], v[168:171]
    ds_read_b64_tr_b16 v[44:45], v24 offset:21696
    ds_read_b64_tr_b16 v[46:47], v24 offset:23488
    s_waitcnt lgkmcnt(10)
    v_mfma_f32_16x16x32_bf16 v[144:147], v[56:59], v[100:103], v[144:147]
    ds_read_b64_tr_b16 v[48:49], v25 offset:0
    ds_read_b64_tr_b16 v[50:51], v25 offset:1792
    s_waitcnt lgkmcnt(10)
    v_mfma_f32_16x16x32_bf16 v[172:175], v[60:63], v[100:103], v[172:175]
    ds_read_b64_tr_b16 v[52:53], v25 offset:7168
    ds_read_b64_tr_b16 v[54:55], v25 offset:8960
    s_waitcnt lgkmcnt(10)
    v_mfma_f32_16x16x32_bf16 v[148:151], v[32:35], v[100:103], v[148:151]
    ds_read_b64_tr_b16 v[56:57], v25 offset:32
    ds_read_b64_tr_b16 v[58:59], v25 offset:1824
    s_waitcnt lgkmcnt(10)
    v_mfma_f32_16x16x32_bf16 v[176:179], v[36:39], v[100:103], v[176:179]
    ds_read_b64_tr_b16 v[60:61], v25 offset:7200
    ds_read_b64_tr_b16 v[62:63], v25 offset:8992
    s_waitcnt lgkmcnt(10)
    v_mfma_f32_16x16x32_bf16 v[152:155], v[40:43], v[100:103], v[152:155]
    ds_read_b64_tr_b16 v[32:33], v25 offset:64
    ds_read_b64_tr_b16 v[34:35], v25 offset:1856
    s_waitcnt lgkmcnt(10)
    v_mfma_f32_16x16x32_bf16 v[180:183], v[44:47], v[100:103], v[180:183]
    ds_read_b64_tr_b16 v[36:37], v25 offset:7232
    ds_read_b64_tr_b16 v[38:39], v25 offset:9024
    s_waitcnt vmcnt(4)
    s_barrier
    s_waitcnt vmcnt(38)
    s_waitcnt lgkmcnt(10)
    v_mfma_f32_16x16x32_bf16 v[128:131], v[48:51], v[104:107], v[128:131]
    ds_read_b64_tr_b16 v[40:41], v25 offset:96
    ds_read_b64_tr_b16 v[42:43], v25 offset:1888
    s_waitcnt lgkmcnt(10)
    v_mfma_f32_16x16x32_bf16 v[156:159], v[52:55], v[104:107], v[156:159]
    ds_read_b64_tr_b16 v[44:45], v25 offset:7264
    ds_read_b64_tr_b16 v[46:47], v25 offset:9056
    s_waitcnt lgkmcnt(10)
    v_mfma_f32_16x16x32_bf16 v[132:135], v[56:59], v[104:107], v[132:135]
    ds_read_b64_tr_b16 v[48:49], v25 offset:128
    ds_read_b64_tr_b16 v[50:51], v25 offset:1920
    s_waitcnt lgkmcnt(10)
    v_mfma_f32_16x16x32_bf16 v[160:163], v[60:63], v[104:107], v[160:163]
    ds_read_b64_tr_b16 v[52:53], v25 offset:7296
    ds_read_b64_tr_b16 v[54:55], v25 offset:9088
    s_waitcnt lgkmcnt(10)
    v_mfma_f32_16x16x32_bf16 v[136:139], v[32:35], v[104:107], v[136:139]
    ds_read_b64_tr_b16 v[56:57], v25 offset:160
    ds_read_b64_tr_b16 v[58:59], v25 offset:1952
    s_waitcnt lgkmcnt(10)
    v_mfma_f32_16x16x32_bf16 v[164:167], v[36:39], v[104:107], v[164:167]
    ds_read_b64_tr_b16 v[60:61], v25 offset:7328
    ds_read_b64_tr_b16 v[62:63], v25 offset:9120
    s_waitcnt lgkmcnt(10)
    v_mfma_f32_16x16x32_bf16 v[140:143], v[40:43], v[104:107], v[140:143]
    ds_read_b64_tr_b16 v[32:33], v25 offset:192
    ds_read_b64_tr_b16 v[34:35], v25 offset:1984
    s_waitcnt lgkmcnt(10)
    v_mfma_f32_16x16x32_bf16 v[168:171], v[44:47], v[104:107], v[168:171]
    ds_read_b64_tr_b16 v[36:37], v25 offset:7360
    ds_read_b64_tr_b16 v[38:39], v25 offset:9152
    s_waitcnt lgkmcnt(10)
    v_mfma_f32_16x16x32_bf16 v[144:147], v[48:51], v[104:107], v[144:147]
    ds_read_b64_tr_b16 v[40:41], v25 offset:14336
    ds_read_b64_tr_b16 v[42:43], v25 offset:16128
    s_waitcnt lgkmcnt(10)
    v_mfma_f32_16x16x32_bf16 v[172:175], v[52:55], v[104:107], v[172:175]
    ds_read_b64_tr_b16 v[44:45], v25 offset:21504
    ds_read_b64_tr_b16 v[46:47], v25 offset:23296
    s_waitcnt lgkmcnt(10)
    v_mfma_f32_16x16x32_bf16 v[148:151], v[56:59], v[104:107], v[148:151]
    ds_read_b64_tr_b16 v[48:49], v25 offset:14368
    ds_read_b64_tr_b16 v[50:51], v25 offset:16160
    s_waitcnt lgkmcnt(10)
    v_mfma_f32_16x16x32_bf16 v[176:179], v[60:63], v[104:107], v[176:179]
    ds_read_b64_tr_b16 v[52:53], v25 offset:21536
    ds_read_b64_tr_b16 v[54:55], v25 offset:23328
    s_waitcnt lgkmcnt(10)
    v_mfma_f32_16x16x32_bf16 v[152:155], v[32:35], v[104:107], v[152:155]
    ds_read_b64_tr_b16 v[56:57], v25 offset:14400
    ds_read_b64_tr_b16 v[58:59], v25 offset:16192
    s_waitcnt lgkmcnt(10)
    v_mfma_f32_16x16x32_bf16 v[180:183], v[36:39], v[104:107], v[180:183]
    ds_read_b64_tr_b16 v[60:61], v25 offset:21568
    ds_read_b64_tr_b16 v[62:63], v25 offset:23360
    s_waitcnt vmcnt(37)
    s_waitcnt lgkmcnt(10)
    v_mfma_f32_16x16x32_bf16 v[128:131], v[40:43], v[108:111], v[128:131]
    ds_read_b64_tr_b16 v[32:33], v25 offset:14432
    ds_read_b64_tr_b16 v[34:35], v25 offset:16224
    s_waitcnt lgkmcnt(10)
    v_mfma_f32_16x16x32_bf16 v[156:159], v[44:47], v[108:111], v[156:159]
    ds_read_b64_tr_b16 v[36:37], v25 offset:21600
    ds_read_b64_tr_b16 v[38:39], v25 offset:23392
    s_waitcnt lgkmcnt(10)
    v_mfma_f32_16x16x32_bf16 v[132:135], v[48:51], v[108:111], v[132:135]
    ds_read_b64_tr_b16 v[40:41], v25 offset:14464
    ds_read_b64_tr_b16 v[42:43], v25 offset:16256
    s_waitcnt lgkmcnt(10)
    v_mfma_f32_16x16x32_bf16 v[160:163], v[52:55], v[108:111], v[160:163]
    ds_read_b64_tr_b16 v[44:45], v25 offset:21632
    ds_read_b64_tr_b16 v[46:47], v25 offset:23424
    s_waitcnt lgkmcnt(10)
    v_mfma_f32_16x16x32_bf16 v[136:139], v[56:59], v[108:111], v[136:139]
    ds_read_b64_tr_b16 v[48:49], v25 offset:14496
    ds_read_b64_tr_b16 v[50:51], v25 offset:16288
    s_waitcnt lgkmcnt(10)
    v_mfma_f32_16x16x32_bf16 v[164:167], v[60:63], v[108:111], v[164:167]
    ds_read_b64_tr_b16 v[52:53], v25 offset:21664
    ds_read_b64_tr_b16 v[54:55], v25 offset:23456
    s_waitcnt lgkmcnt(10)
    v_mfma_f32_16x16x32_bf16 v[140:143], v[32:35], v[108:111], v[140:143]
    ds_read_b64_tr_b16 v[56:57], v25 offset:14528
    ds_read_b64_tr_b16 v[58:59], v25 offset:16320
    s_waitcnt lgkmcnt(10)
    v_mfma_f32_16x16x32_bf16 v[168:171], v[36:39], v[108:111], v[168:171]
    ds_read_b64_tr_b16 v[60:61], v25 offset:21696
    ds_read_b64_tr_b16 v[62:63], v25 offset:23488
    s_waitcnt lgkmcnt(10)
    v_mfma_f32_16x16x32_bf16 v[144:147], v[40:43], v[108:111], v[144:147]
    ds_read_b64_tr_b16 v[32:33], v26 offset:0
    ds_read_b64_tr_b16 v[34:35], v26 offset:1792
    s_waitcnt lgkmcnt(10)
    v_mfma_f32_16x16x32_bf16 v[172:175], v[44:47], v[108:111], v[172:175]
    ds_read_b64_tr_b16 v[36:37], v26 offset:7168
    ds_read_b64_tr_b16 v[38:39], v26 offset:8960
    s_waitcnt lgkmcnt(10)
    v_mfma_f32_16x16x32_bf16 v[148:151], v[48:51], v[108:111], v[148:151]
    ds_read_b64_tr_b16 v[40:41], v26 offset:32
    ds_read_b64_tr_b16 v[42:43], v26 offset:1824
    s_waitcnt lgkmcnt(10)
    v_mfma_f32_16x16x32_bf16 v[176:179], v[52:55], v[108:111], v[176:179]
    ds_read_b64_tr_b16 v[44:45], v26 offset:7200
    ds_read_b64_tr_b16 v[46:47], v26 offset:8992
    s_waitcnt lgkmcnt(10)
    v_mfma_f32_16x16x32_bf16 v[152:155], v[56:59], v[108:111], v[152:155]
    ds_read_b64_tr_b16 v[48:49], v26 offset:64
    ds_read_b64_tr_b16 v[50:51], v26 offset:1856
    s_waitcnt lgkmcnt(10)
    v_mfma_f32_16x16x32_bf16 v[180:183], v[60:63], v[108:111], v[180:183]
    ds_read_b64_tr_b16 v[52:53], v26 offset:7232
    ds_read_b64_tr_b16 v[54:55], v26 offset:9024
    s_waitcnt vmcnt(0)
    s_barrier
    v_lshlrev_b32 v10, 8, v2
    v_add_u32 v10, 10240, v10
    s_mov_b32 s99, 0
LwaitW:
    buffer_load_dword v11, v10, s[12:15], 0 offen sc1
    s_waitcnt vmcnt(0)
    v_cmp_gt_u32 vcc, 16, v11
    s_nop 4
    s_cbranch_vccz LwaitW_ok
    s_sleep 1
    s_add_u32 s99, s99, 1
    s_cmp_lt_u32 s99, 0x8000
    s_cbranch_scc1 LwaitW
LwaitW_ok:
    s_waitcnt vmcnt(28)
    s_waitcnt lgkmcnt(10)
    v_mfma_f32_16x16x32_bf16 v[128:131], v[32:35], v[112:115], v[128:131]
    ds_read_b64_tr_b16 v[56:57], v26 offset:96
    ds_read_b64_tr_b16 v[58:59], v26 offset:1888
    s_waitcnt lgkmcnt(10)
    v_mfma_f32_16x16x32_bf16 v[156:159], v[36:39], v[112:115], v[156:159]
    ds_read_b64_tr_b16 v[60:61], v26 offset:7264
    ds_read_b64_tr_b16 v[62:63], v26 offset:9056
    s_waitcnt lgkmcnt(10)
    v_mfma_f32_16x16x32_bf16 v[132:135], v[40:43], v[112:115], v[132:135]
    ds_read_b64_tr_b16 v[32:33], v26 offset:128
    ds_read_b64_tr_b16 v[34:35], v26 offset:1920
    s_mul_i32 s72, s3, 7
    s_add_u32 s72, s72, 0
    s_lshl_b32 s72, s72, 5
    s_lshl_b32 s73, s65, 2
    s_add_u32 s72, s72, s73
    s_lshl_b32 s72, s72, 10
    s_add_u32 s72, s72, 8388608
    buffer_load_dwordx4 v[192:195], v5, s[12:15], s72 offen offset:0 sc1
    s_waitcnt lgkmcnt(10)
    v_mfma_f32_16x16x32_bf16 v[160:163], v[44:47], v[112:115], v[160:163]
    ds_read_b64_tr_b16 v[36:37], v26 offset:7296
    ds_read_b64_tr_b16 v[38:39], v26 offset:9088
    s_waitcnt lgkmcnt(10)
    v_mfma_f32_16x16x32_bf16 v[136:139], v[48:51], v[112:115], v[136:139]
    ds_read_b64_tr_b16 v[40:41], v26 offset:160
    ds_read_b64_tr_b16 v[42:43], v26 offset:1952
    s_waitcnt lgkmcnt(10)
    v_mfma_f32_16x16x32_bf16 v[164:167], v[52:55], v[112:115], v[164:167]
    ds_read_b64_tr_b16 v[44:45], v26 offset:7328
    ds_read_b64_tr_b16 v[46:47], v26 offset:9120
    buffer_load_dwordx4 v[196:199], v5, s[12:15], s72 offen offset:1024 sc1
    s_waitcnt lgkmcnt(10)
    v_mfma_f32_16x16x32_bf16 v[140:143], v[56:59], v[112:115], v[140:143]
    ds_read_b64_tr_b16 v[48:49], v26 offset:192
    ds_read_b64_tr_b16 v[50:51], v26 offset:1984
    s_waitcnt lgkmcnt(10)
    v_mfma_f32_16x16x32_bf16 v[168:171], v[60:63], v[112:115], v[168:171]
    ds_read_b64_tr_b16 v[52:53], v26 offset:7360
    ds_read_b64_tr_b16 v[54:55], v26 offset:9152
    s_waitcnt lgkmcnt(10)
    v_mfma_f32_16x16x32_bf16 v[144:147], v[32:35], v[112:115], v[144:147]
    ds_read_b64_tr_b16 v[56:57], v26 offset:14336
    ds_read_b64_tr_b16 v[58:59], v26 offset:16128
    buffer_load_dwordx4 v[200:203], v5, s[12:15], s72 offen offset:2048 sc1
    s_waitcnt lgkmcnt(10)
    v_mfma_f32_16x16x32_bf16 v[172:175], v[36:39], v[112:115], v[172:175]
    ds_read_b64_tr_b16 v[60:61], v26 offset:21504
    ds_read_b64_tr_b16 v[62:63], v26 offset:23296
    s_waitcnt lgkmcnt(10)
    v_mfma_f32_16x16x32_bf16 v[148:151], v[40:43], v[112:115], v[148:151]
    ds_read_b64_tr_b16 v[32:33], v26 offset:14368
    ds_read_b64_tr_b16 v[34:35], v26 offset:16160
    s_waitcnt lgkmcnt(10)
    v_mfma_f32_16x16x32_bf16 v[176:179], v[44:47], v[112:115], v[176:179]
    ds_read_b64_tr_b16 v[36:37], v26 offset:21536
    ds_read_b64_tr_b16 v[38:39], v26 offset:23328
    buffer_load_dwordx4 v[204:207], v5, s[12:15], s72 offen offset:3072 sc1
    s_add_u32 s72, s72, 32768
    s_waitcnt lgkmcnt(10)
    v_mfma_f32_16x16x32_bf16 v[152:155], v[48:51], v[112:115], v[152:155]
    ds_read_b64_tr_b16 v[40:41], v26 offset:14400
    ds_read_b64_tr_b16 v[42:43], v26 offset:16192
    s_waitcnt lgkmcnt(10)
    v_mfma_f32_16x16x32_bf16 v[180:183], v[52:55], v[112:115], v[180:183]
    ds_read_b64_tr_b16 v[44:45], v26 offset:21568
    ds_read_b64_tr_b16 v[46:47], v26 offset:23360
    s_waitcnt vmcnt(31)
    s_waitcnt lgkmcnt(10)
    v_mfma_f32_16x16x32_bf16 v[128:131], v[56:59], v[116:119], v[128:131]
    ds_read_b64_tr_b16 v[48:49], v26 offset:14432
    ds_read_b64_tr_b16 v[50:51], v26 offset:16224
    buffer_load_dwordx4 v[208:211], v5, s[12:15], s72 offen offset:0 sc1
    s_waitcnt lgkmcnt(10)
    v_mfma_f32_16x16x32_bf16 v[156:159], v[60:63], v[116:119], v[156:159]
    ds_read_b64_tr_b16 v[52:53], v26 offset:21600
    ds_read_b64_tr_b16 v[54:55], v26 offset:23392
    s_waitcnt lgkmcnt(10)
    v_mfma_f32_16x16x32_bf16 v[132:135], v[32:35], v[116:119], v[132:135]
    ds_read_b64_tr_b16 v[56:57], v26 offset:14464
    ds_read_b64_tr_b16 v[58:59], v26 offset:16256
    s_waitcnt lgkmcnt(10)
    v_mfma_f32_16x16x32_bf16 v[160:163], v[36:39], v[116:119], v[160:163]
    ds_read_b64_tr_b16 v[60:61], v26 offset:21632
    ds_read_b64_tr_b16 v[62:63], v26 offset:23424
    buffer_load_dwordx4 v[212:215], v5, s[12:15], s72 offen offset:1024 sc1
    s_waitcnt lgkmcnt(10)
    v_mfma_f32_16x16x32_bf16 v[136:139], v[40:43], v[116:119], v[136:139]
    ds_read_b64_tr_b16 v[32:33], v26 offset:14496
    ds_read_b64_tr_b16 v[34:35], v26 offset:16288
    s_waitcnt lgkmcnt(10)
    v_mfma_f32_16x16x32_bf16 v[164:167], v[44:47], v[116:119], v[164:167]
    ds_read_b64_tr_b16 v[36:37], v26 offset:21664
    ds_read_b64_tr_b16 v[38:39], v26 offset:23456
    s_waitcnt lgkmcnt(10)
    v_mfma_f32_16x16x32_bf16 v[140:143], v[48:51], v[116:119], v[140:143]
    ds_read_b64_tr_b16 v[40:41], v26 offset:14528
    ds_read_b64_tr_b16 v[42:43], v26 offset:16320
    buffer_load_dwordx4 v[216:219], v5, s[12:15], s72 offen offset:2048 sc1
    s_waitcnt lgkmcnt(10)
    v_mfma_f32_16x16x32_bf16 v[168:171], v[52:55], v[116:119], v[168:171]
    ds_read_b64_tr_b16 v[44:45], v26 offset:21696
    ds_read_b64_tr_b16 v[46:47], v26 offset:23488
    s_waitcnt lgkmcnt(10)
    v_mfma_f32_16x16x32_bf16 v[144:147], v[56:59], v[116:119], v[144:147]
    ds_read_b64_tr_b16 v[48:49], v27 offset:0
    ds_read_b64_tr_b16 v[50:51], v27 offset:1792
    s_waitcnt lgkmcnt(10)
    v_mfma_f32_16x16x32_bf16 v[172:175], v[60:63], v[116:119], v[172:175]
    ds_read_b64_tr_b16 v[52:53], v27 offset:7168
    ds_read_b64_tr_b16 v[54:55], v27 offset:8960
    buffer_load_dwordx4 v[220:223], v5, s[12:15], s72 offen offset:3072 sc1
    s_add_u32 s72, s72, 32768
    s_waitcnt lgkmcnt(10)
    v_mfma_f32_16x16x32_bf16 v[148:151], v[32:35], v[116:119], v[148:151]
    ds_read_b64_tr_b16 v[56:57], v27 offset:32
    ds_read_b64_tr_b16 v[58:59], v27 offset:1824
    s_waitcnt lgkmcnt(10)
    v_mfma_f32_16x16x32_bf16 v[176:179], v[36:39], v[116:119], v[176:179]
    ds_read_b64_tr_b16 v[60:61], v27 offset:7200
    ds_read_b64_tr_b16 v[62:63], v27 offset:8992
    s_waitcnt lgkmcnt(10)
    v_mfma_f32_16x16x32_bf16 v[152:155], v[40:43], v[116:119], v[152:155]
    ds_read_b64_tr_b16 v[32:33], v27 offset:64
    ds_read_b64_tr_b16 v[34:35], v27 offset:1856
    buffer_load_dwordx4 v[224:227], v5, s[12:15], s72 offen offset:0 sc1
    s_waitcnt lgkmcnt(10)
    v_mfma_f32_16x16x32_bf16 v[180:183], v[44:47], v[116:119], v[180:183]
    ds_read_b64_tr_b16 v[36:37], v27 offset:7232
    ds_read_b64_tr_b16 v[38:39], v27 offset:9024
    s_waitcnt vmcnt(9)
    s_barrier
    s_waitcnt vmcnt(35)
    s_waitcnt lgkmcnt(10)
    v_mfma_f32_16x16x32_bf16 v[128:131], v[48:51], v[120:123], v[128:131]
    ds_read_b64_tr_b16 v[40:41], v27 offset:96
    ds_read_b64_tr_b16 v[42:43], v27 offset:1888
    s_waitcnt lgkmcnt(10)
    v_mfma_f32_16x16x32_bf16 v[156:159], v[52:55], v[120:123], v[156:159]
    ds_read_b64_tr_b16 v[44:45], v27 offset:7264
    ds_read_b64_tr_b16 v[46:47], v27 offset:9056
    buffer_load_dwordx4 v[228:231], v5, s[12:15], s72 offen offset:1024 sc1
    s_waitcnt lgkmcnt(10)
    v_mfma_f32_16x16x32_bf16 v[132:135], v[56:59], v[120:123], v[132:135]
    ds_read_b64_tr_b16 v[48:49], v27 offset:128
    ds_read_b64_tr_b16 v[50:51], v27 offset:1920
    s_waitcnt lgkmcnt(10)
    v_mfma_f32_16x16x32_bf16 v[160:163], v[60:63], v[120:123], v[160:163]
    ds_read_b64_tr_b16 v[52:53], v27 offset:7296
    ds_read_b64_tr_b16 v[54:55], v27 offset:9088
    s_waitcnt lgkmcnt(10)
    v_mfma_f32_16x16x32_bf16 v[136:139], v[32:35], v[120:123], v[136:139]
    ds_read_b64_tr_b16 v[56:57], v27 offset:160
    ds_read_b64_tr_b16 v[58:59], v27 offset:1952
    buffer_load_dwordx4 v[232:235], v5, s[12:15], s72 offen offset:2048 sc1
    s_waitcnt lgkmcnt(10)
    v_mfma_f32_16x16x32_bf16 v[164:167], v[36:39], v[120:123], v[164:167]
    ds_read_b64_tr_b16 v[60:61], v27 offset:7328
    ds_read_b64_tr_b16 v[62:63], v27 offset:9120
    s_waitcnt lgkmcnt(10)
    v_mfma_f32_16x16x32_bf16 v[140:143], v[40:43], v[120:123], v[140:143]
    ds_read_b64_tr_b16 v[32:33], v27 offset:192
    ds_read_b64_tr_b16 v[34:35], v27 offset:1984
    s_waitcnt lgkmcnt(10)
    v_mfma_f32_16x16x32_bf16 v[168:171], v[44:47], v[120:123], v[168:171]
    ds_read_b64_tr_b16 v[36:37], v27 offset:7360
    ds_read_b64_tr_b16 v[38:39], v27 offset:9152
    buffer_load_dwordx4 v[236:239], v5, s[12:15], s72 offen offset:3072 sc1
    s_add_u32 s72, s72, 32768
    s_waitcnt lgkmcnt(10)
    v_mfma_f32_16x16x32_bf16 v[144:147], v[48:51], v[120:123], v[144:147]
    ds_read_b64_tr_b16 v[40:41], v27 offset:14336
    ds_read_b64_tr_b16 v[42:43], v27 offset:16128
    s_waitcnt lgkmcnt(10)
    v_mfma_f32_16x16x32_bf16 v[172:175], v[52:55], v[120:123], v[172:175]
    ds_read_b64_tr_b16 v[44:45], v27 offset:21504
    ds_read_b64_tr_b16 v[46:47], v27 offset:23296
    s_waitcnt lgkmcnt(10)
    v_mfma_f32_16x16x32_bf16 v[148:151], v[56:59], v[120:123], v[148:151]
    ds_read_b64_tr_b16 v[48:49], v27 offset:14368
    ds_read_b64_tr_b16 v[50:51], v27 offset:16160
    buffer_load_dwordx4 v[240:243], v5, s[12:15], s72 offen offset:0 sc1
    s_waitcnt lgkmcnt(10)
    v_mfma_f32_16x16x32_bf16 v[176:179], v[60:63], v[120:123], v[176:179]
    ds_read_b64_tr_b16 v[52:53], v27 offset:21536
    ds_read_b64_tr_b16 v[54:55], v27 offset:23328
    s_waitcnt lgkmcnt(10)
    v_mfma_f32_16x16x32_bf16 v[152:155], v[32:35], v[120:123], v[152:155]
    ds_read_b64_tr_b16 v[56:57], v27 offset:14400
    ds_read_b64_tr_b16 v[58:59], v27 offset:16192
    s_waitcnt lgkmcnt(10)
    v_mfma_f32_16x16x32_bf16 v[180:183], v[36:39], v[120:123], v[180:183]
    ds_read_b64_tr_b16 v[60:61], v27 offset:21568
    ds_read_b64_tr_b16 v[62:63], v27 offset:23360
    buffer_load_dwordx4 v[244:247], v5, s[12:15], s72 offen offset:1024 sc1
    s_waitcnt vmcnt(39)
    s_waitcnt lgkmcnt(10)
    v_mfma_f32_16x16x32_bf16 v[128:131], v[40:43], v[124:127], v[128:131]
    ds_read_b64_tr_b16 v[32:33], v27 offset:14432
    ds_read_b64_tr_b16 v[34:35], v27 offset:16224
    s_waitcnt lgkmcnt(10)
    v_mfma_f32_16x16x32_bf16 v[156:159], v[44:47], v[124:127], v[156:159]
    ds_read_b64_tr_b16 v[36:37], v27 offset:21600
    ds_read_b64_tr_b16 v[38:39], v27 offset:23392
    s_waitcnt lgkmcnt(10)
    v_mfma_f32_16x16x32_bf16 v[132:135], v[48:51], v[124:127], v[132:135]
    ds_read_b64_tr_b16 v[40:41], v27 offset:14464
    ds_read_b64_tr_b16 v[42:43], v27 offset:16256
    buffer_load_dwordx4 v[248:251], v5, s[12:15], s72 offen offset:2048 sc1
    s_waitcnt lgkmcnt(10)
    v_mfma_f32_16x16x32_bf16 v[160:163], v[52:55], v[124:127], v[160:163]
    ds_read_b64_tr_b16 v[44:45], v27 offset:21632
    ds_read_b64_tr_b16 v[46:47], v27 offset:23424
    s_waitcnt lgkmcnt(10)
    v_mfma_f32_16x16x32_bf16 v[136:139], v[56:59], v[124:127], v[136:139]
    ds_read_b64_tr_b16 v[48:49], v27 offset:14496
    ds_read_b64_tr_b16 v[50:51], v27 offset:16288
    s_waitcnt lgkmcnt(10)
    v_mfma_f32_16x16x32_bf16 v[164:167], v[60:63], v[124:127], v[164:167]
    ds_read_b64_tr_b16 v[52:53], v27 offset:21664
    ds_read_b64_tr_b16 v[54:55], v27 offset:23456
    buffer_load_dwordx4 v[252:255], v5, s[12:15], s72 offen offset:3072 sc1
    s_add_u32 s72, s72, 32768
    s_waitcnt lgkmcnt(10)
    v_mfma_f32_16x16x32_bf16 v[140:143], v[32:35], v[124:127], v[140:143]
    ds_read_b64_tr_b16 v[56:57], v27 offset:14528
    ds_read_b64_tr_b16 v[58:59], v27 offset:16320
    s_waitcnt lgkmcnt(10)
    v_mfma_f32_16x16x32_bf16 v[168:171], v[36:39], v[124:127], v[168:171]
    ds_read_b64_tr_b16 v[60:61], v27 offset:21696
    ds_read_b64_tr_b16 v[62:63], v27 offset:23488
    s_waitcnt lgkmcnt(10)
    v_mfma_f32_16x16x32_bf16 v[144:147], v[40:43], v[124:127], v[144:147]
    s_waitcnt lgkmcnt(8)
    v_mfma_f32_16x16x32_bf16 v[172:175], v[44:47], v[124:127], v[172:175]
    s_waitcnt lgkmcnt(6)
    v_mfma_f32_16x16x32_bf16 v[148:151], v[48:51], v[124:127], v[148:151]
    s_waitcnt lgkmcnt(4)
    v_mfma_f32_16x16x32_bf16 v[176:179], v[52:55], v[124:127], v[176:179]
    s_waitcnt lgkmcnt(2)
    v_mfma_f32_16x16x32_bf16 v[152:155], v[56:59], v[124:127], v[152:155]
    s_waitcnt lgkmcnt(0)
    v_mfma_f32_16x16x32_bf16 v[180:183], v[60:63], v[124:127], v[180:183]
    v_lshlrev_b32 v62, 2, v1
    v_mov_b32 v63, 0
    s_lshl_b32 s76, s67, 9
    s_add_u32 s76, s76, 256
    s_lshl_b32 s78, s67, 2
    s_mov_b32 s36, s46
    s_and_b32 s37, s47, 0xffff
    s_mov_b32 s38, 131072
    s_mov_b32 s39, 0x00020000
    buffer_load_dword v48, v62, s[36:39], s76 offen
    s_mov_b32 s40, s48
    s_and_b32 s41, s49, 0xffff
    s_mov_b32 s42, 131072
    s_mov_b32 s43, 0x00020000
    buffer_load_dword v49, v62, s[40:43], s76 offen
    s_mov_b32 s36, s50
    s_and_b32 s37, s51, 0xffff
    s_mov_b32 s38, 131072
    s_mov_b32 s39, 0x00020000
    buffer_load_dword v50, v62, s[36:39], s76 offen
    s_mov_b32 s40, s52
    s_and_b32 s41, s53, 0xffff
    s_mov_b32 s42, 131072
    s_mov_b32 s43, 0x00020000
    buffer_load_dword v51, v62, s[40:43], s76 offen
    s_mov_b32 s36, s54
    s_and_b32 s37, s55, 0xffff
    s_mov_b32 s38, 131072
    s_mov_b32 s39, 0x00020000
    buffer_load_dword v52, v62, s[36:39], s76 offen
    s_mov_b32 s40, s56
    s_and_b32 s41, s57, 0xffff
    s_mov_b32 s42, 131072
    s_mov_b32 s43, 0x00020000
    buffer_load_dword v53, v62, s[40:43], s76 offen
    s_lshl_b32 s78, s4, 3
    s_add_u32 s78, s78, s3
    s_mul_i32 s78, s78, 57344
    s_add_u32 s78, s78, 16777216
    s_lshr_b32 s79, s5, 1
    s_mul_i32 s79, s79, 7
    s_and_b32 s80, s5, 1
    s_mul_i32 s81, s80, 3
    s_add_u32 s81, s81, s79
    s_lshl_b32 s81, s81, 10
    s_add_u32 s81, s81, s78
    s_add_u32 s83, s79, 6
    s_lshl_b32 s83, s83, 10
    s_add_u32 s83, s83, s78
    s_lshl_b32 s80, s80, 3
    s_add_u32 s83, s83, s80
    v_mov_b32 v38, 3216550459
    v_cvt_pk_bf16_f32 v32, v128, v129
    v_cvt_pk_bf16_f32 v33, v156, v157
    v_lshlrev_b32 v34, 16, v32
    v_and_b32 v35, 0xffff0000, v32
    v_mul_f32 v34, v38, v34
    v_mul_f32 v35, v38, v35
    v_exp_f32 v34, v34
    v_exp_f32 v35, v35
    v_lshlrev_b32 v36, 16, v33
    v_and_b32 v37, 0xffff0000, v33
    v_add_f32 v34, 1.0, v34
    v_add_f32 v35, 1.0, v35
    v_rcp_f32 v34, v34
    v_rcp_f32 v35, v35
    s_nop 0
    v_cvt_pk_bf16_f32 v32, v34, v35
    v_lshlrev_b32 v34, 16, v32
    v_and_b32 v35, 0xffff0000, v32
    v_mul_f32 v34, v34, v36
    v_mul_f32 v35, v35, v37
    v_cvt_pk_bf16_f32 v8, v34, v35
    v_cvt_pk_bf16_f32 v32, v130, v131
    v_cvt_pk_bf16_f32 v33, v158, v159
    v_lshlrev_b32 v34, 16, v32
    v_and_b32 v35, 0xffff0000, v32
    v_mul_f32 v34, v38, v34
    v_mul_f32 v35, v38, v35
    v_exp_f32 v34, v34
    v_exp_f32 v35, v35
    v_lshlrev_b32 v36, 16, v33
    v_and_b32 v37, 0xffff0000, v33
    v_add_f32 v34, 1.0, v34
    v_add_f32 v35, 1.0, v35
    v_rcp_f32 v34, v34
    v_rcp_f32 v35, v35
    s_nop 0
    v_cvt_pk_bf16_f32 v32, v34, v35
    v_lshlrev_b32 v34, 16, v32
    v_and_b32 v35, 0xffff0000, v32
    v_mul_f32 v34, v34, v36
    v_mul_f32 v35, v35, v37
    v_cvt_pk_bf16_f32 v9, v34, v35
    v_cvt_pk_bf16_f32 v32, v132, v133
    v_cvt_pk_bf16_f32 v33, v160, v161
    v_lshlrev_b32 v34, 16, v32
    v_and_b32 v35, 0xffff0000, v32
    v_mul_f32 v34, v38, v34
    v_mul_f32 v35, v38, v35
    v_exp_f32 v34, v34
    v_exp_f32 v35, v35
    v_lshlrev_b32 v36, 16, v33
    v_and_b32 v37, 0xffff0000, v33
    v_add_f32 v34, 1.0, v34
    v_add_f32 v35, 1.0, v35
    v_rcp_f32 v34, v34
    v_rcp_f32 v35, v35
    s_nop 0
    v_cvt_pk_bf16_f32 v32, v34, v35
    v_lshlrev_b32 v34, 16, v32
    v_and_b32 v35, 0xffff0000, v32
    v_mul_f32 v34, v34, v36
    v_mul_f32 v35, v35, v37
    v_cvt_pk_bf16_f32 v10, v34, v35
    v_cvt_pk_bf16_f32 v32, v134, v135
    v_cvt_pk_bf16_f32 v33, v162, v163
    v_lshlrev_b32 v34, 16, v32
    v_and_b32 v35, 0xffff0000, v32
    v_mul_f32 v34, v38, v34
    v_mul_f32 v35, v38, v35
    v_exp_f32 v34, v34
    v_exp_f32 v35, v35
    v_lshlrev_b32 v36, 16, v33
    v_and_b32 v37, 0xffff0000, v33
    v_add_f32 v34, 1.0, v34
    v_add_f32 v35, 1.0, v35
    v_rcp_f32 v34, v34
    v_rcp_f32 v35, v35
    s_nop 0
    v_cvt_pk_bf16_f32 v32, v34, v35
    v_lshlrev_b32 v34, 16, v32
    v_and_b32 v35, 0xffff0000, v32
    v_mul_f32 v34, v34, v36
    v_mul_f32 v35, v35, v37
    v_cvt_pk_bf16_f32 v11, v34, v35
    buffer_store_dwordx4 v[8:11], v5, s[12:15], s81 offen offset:0 sc1
    v_cvt_pk_bf16_f32 v32, v136, v137
    v_cvt_pk_bf16_f32 v33, v164, v165
    v_lshlrev_b32 v34, 16, v32
    v_and_b32 v35, 0xffff0000, v32
    v_mul_f32 v34, v38, v34
    v_mul_f32 v35, v38, v35
    v_exp_f32 v34, v34
    v_exp_f32 v35, v35
    v_lshlrev_b32 v36, 16, v33
    v_and_b32 v37, 0xffff0000, v33
    v_add_f32 v34, 1.0, v34
    v_add_f32 v35, 1.0, v35
    v_rcp_f32 v34, v34
    v_rcp_f32 v35, v35
    s_nop 0
    v_cvt_pk_bf16_f32 v32, v34, v35
    v_lshlrev_b32 v34, 16, v32
    v_and_b32 v35, 0xffff0000, v32
    v_mul_f32 v34, v34, v36
    v_mul_f32 v35, v35, v37
    v_cvt_pk_bf16_f32 v12, v34, v35
    v_cvt_pk_bf16_f32 v32, v138, v139
    v_cvt_pk_bf16_f32 v33, v166, v167
    v_lshlrev_b32 v34, 16, v32
    v_and_b32 v35, 0xffff0000, v32
    v_mul_f32 v34, v38, v34
    v_mul_f32 v35, v38, v35
    v_exp_f32 v34, v34
    v_exp_f32 v35, v35
    v_lshlrev_b32 v36, 16, v33
    v_and_b32 v37, 0xffff0000, v33
    v_add_f32 v34, 1.0, v34
    v_add_f32 v35, 1.0, v35
    v_rcp_f32 v34, v34
    v_rcp_f32 v35, v35
    s_nop 0
    v_cvt_pk_bf16_f32 v32, v34, v35
    v_lshlrev_b32 v34, 16, v32
    v_and_b32 v35, 0xffff0000, v32
    v_mul_f32 v34, v34, v36
    v_mul_f32 v35, v35, v37
    v_cvt_pk_bf16_f32 v13, v34, v35
    v_cvt_pk_bf16_f32 v32, v140, v141
    v_cvt_pk_bf16_f32 v33, v168, v169
    v_lshlrev_b32 v34, 16, v32
    v_and_b32 v35, 0xffff0000, v32
    v_mul_f32 v34, v38, v34
    v_mul_f32 v35, v38, v35
    v_exp_f32 v34, v34
    v_exp_f32 v35, v35
    v_lshlrev_b32 v36, 16, v33
    v_and_b32 v37, 0xffff0000, v33
    v_add_f32 v34, 1.0, v34
    v_add_f32 v35, 1.0, v35
    v_rcp_f32 v34, v34
    v_rcp_f32 v35, v35
    s_nop 0
    v_cvt_pk_bf16_f32 v32, v34, v35
    v_lshlrev_b32 v34, 16, v32
    v_and_b32 v35, 0xffff0000, v32
    v_mul_f32 v34, v34, v36
    v_mul_f32 v35, v35, v37
    v_cvt_pk_bf16_f32 v14, v34, v35
    v_cvt_pk_bf16_f32 v32, v142, v143
    v_cvt_pk_bf16_f32 v33, v170, v171
    v_lshlrev_b32 v34, 16, v32
    v_and_b32 v35, 0xffff0000, v32
    v_mul_f32 v34, v38, v34
    v_mul_f32 v35, v38, v35
    v_exp_f32 v34, v34
    v_exp_f32 v35, v35
    v_lshlrev_b32 v36, 16, v33
    v_and_b32 v37, 0xffff0000, v33
    v_add_f32 v34, 1.0, v34
    v_add_f32 v35, 1.0, v35
    v_rcp_f32 v34, v34
    v_rcp_f32 v35, v35
    s_nop 0
    v_cvt_pk_bf16_f32 v32, v34, v35
    v_lshlrev_b32 v34, 16, v32
    v_and_b32 v35, 0xffff0000, v32
    v_mul_f32 v34, v34, v36
    v_mul_f32 v35, v35, v37
    v_cvt_pk_bf16_f32 v15, v34, v35
    buffer_store_dwordx4 v[12:15], v5, s[12:15], s81 offen offset:1024 sc1
    v_cvt_pk_bf16_f32 v32, v144, v145
    v_cvt_pk_bf16_f32 v33, v172, v173
    v_lshlrev_b32 v34, 16, v32
    v_and_b32 v35, 0xffff0000, v32
    v_mul_f32 v34, v38, v34
    v_mul_f32 v35, v38, v35
    v_exp_f32 v34, v34
    v_exp_f32 v35, v35
    v_lshlrev_b32 v36, 16, v33
    v_and_b32 v37, 0xffff0000, v33
    v_add_f32 v34, 1.0, v34
    v_add_f32 v35, 1.0, v35
    v_rcp_f32 v34, v34
    v_rcp_f32 v35, v35
    s_nop 0
    v_cvt_pk_bf16_f32 v32, v34, v35
    v_lshlrev_b32 v34, 16, v32
    v_and_b32 v35, 0xffff0000, v32
    v_mul_f32 v34, v34, v36
    v_mul_f32 v35, v35, v37
    v_cvt_pk_bf16_f32 v16, v34, v35
    v_cvt_pk_bf16_f32 v32, v146, v147
    v_cvt_pk_bf16_f32 v33, v174, v175
    v_lshlrev_b32 v34, 16, v32
    v_and_b32 v35, 0xffff0000, v32
    v_mul_f32 v34, v38, v34
    v_mul_f32 v35, v38, v35
    v_exp_f32 v34, v34
    v_exp_f32 v35, v35
    v_lshlrev_b32 v36, 16, v33
    v_and_b32 v37, 0xffff0000, v33
    v_add_f32 v34, 1.0, v34
    v_add_f32 v35, 1.0, v35
    v_rcp_f32 v34, v34
    v_rcp_f32 v35, v35
    s_nop 0
    v_cvt_pk_bf16_f32 v32, v34, v35
    v_lshlrev_b32 v34, 16, v32
    v_and_b32 v35, 0xffff0000, v32
    v_mul_f32 v34, v34, v36
    v_mul_f32 v35, v35, v37
    v_cvt_pk_bf16_f32 v17, v34, v35
    v_cvt_pk_bf16_f32 v32, v148, v149
    v_cvt_pk_bf16_f32 v33, v176, v177
    v_lshlrev_b32 v34, 16, v32
    v_and_b32 v35, 0xffff0000, v32
    v_mul_f32 v34, v38, v34
    v_mul_f32 v35, v38, v35
    v_exp_f32 v34, v34
    v_exp_f32 v35, v35
    v_lshlrev_b32 v36, 16, v33
    v_and_b32 v37, 0xffff0000, v33
    v_add_f32 v34, 1.0, v34
    v_add_f32 v35, 1.0, v35
    v_rcp_f32 v34, v34
    v_rcp_f32 v35, v35
    s_nop 0
    v_cvt_pk_bf16_f32 v32, v34, v35
    v_lshlrev_b32 v34, 16, v32
    v_and_b32 v35, 0xffff0000, v32
    v_mul_f32 v34, v34, v36
    v_mul_f32 v35, v35, v37
    v_cvt_pk_bf16_f32 v18, v34, v35
    v_cvt_pk_bf16_f32 v32, v150, v151
    v_cvt_pk_bf16_f32 v33, v178, v179
    v_lshlrev_b32 v34, 16, v32
    v_and_b32 v35, 0xffff0000, v32
    v_mul_f32 v34, v38, v34
    v_mul_f32 v35, v38, v35
    v_exp_f32 v34, v34
    v_exp_f32 v35, v35
    v_lshlrev_b32 v36, 16, v33
    v_and_b32 v37, 0xffff0000, v33
    v_add_f32 v34, 1.0, v34
    v_add_f32 v35, 1.0, v35
    v_rcp_f32 v34, v34
    v_rcp_f32 v35, v35
    s_nop 0
    v_cvt_pk_bf16_f32 v32, v34, v35
    v_lshlrev_b32 v34, 16, v32
    v_and_b32 v35, 0xffff0000, v32
    v_mul_f32 v34, v34, v36
    v_mul_f32 v35, v35, v37
    v_cvt_pk_bf16_f32 v19, v34, v35
    buffer_store_dwordx4 v[16:19], v5, s[12:15], s81 offen offset:2048 sc1
    v_cvt_pk_bf16_f32 v32, v152, v153
    v_cvt_pk_bf16_f32 v33, v180, v181
    v_lshlrev_b32 v34, 16, v32
    v_and_b32 v35, 0xffff0000, v32
    v_mul_f32 v34, v38, v34
    v_mul_f32 v35, v38, v35
    v_exp_f32 v34, v34
    v_exp_f32 v35, v35
    v_lshlrev_b32 v36, 16, v33
    v_and_b32 v37, 0xffff0000, v33
    v_add_f32 v34, 1.0, v34
    v_add_f32 v35, 1.0, v35
    v_rcp_f32 v34, v34
    v_rcp_f32 v35, v35
    s_nop 0
    v_cvt_pk_bf16_f32 v32, v34, v35
    v_lshlrev_b32 v34, 16, v32
    v_and_b32 v35, 0xffff0000, v32
    v_mul_f32 v34, v34, v36
    v_mul_f32 v35, v35, v37
    v_cvt_pk_bf16_f32 v20, v34, v35
    v_cvt_pk_bf16_f32 v32, v154, v155
    v_cvt_pk_bf16_f32 v33, v182, v183
    v_lshlrev_b32 v34, 16, v32
    v_and_b32 v35, 0xffff0000, v32
    v_mul_f32 v34, v38, v34
    v_mul_f32 v35, v38, v35
    v_exp_f32 v34, v34
    v_exp_f32 v35, v35
    v_lshlrev_b32 v36, 16, v33
    v_and_b32 v37, 0xffff0000, v33
    v_add_f32 v34, 1.0, v34
    v_add_f32 v35, 1.0, v35
    v_rcp_f32 v34, v34
    v_rcp_f32 v35, v35
    s_nop 0
    v_cvt_pk_bf16_f32 v32, v34, v35
    v_lshlrev_b32 v34, 16, v32
    v_and_b32 v35, 0xffff0000, v32
    v_mul_f32 v34, v34, v36
    v_mul_f32 v35, v35, v37
    v_cvt_pk_bf16_f32 v21, v34, v35
    buffer_store_dwordx2 v[20:21], v5, s[12:15], s83 offen sc1
    s_barrier
    s_and_b32 s76, s3, 1
    s_lshl_b32 s77, s76, 4
    s_lshr_b32 s78, s3, 1
    s_mov_b32 s79, 0
    s_mov_b32 s80, 0x41800000
    s_mov_b32 s81, 0
    s_mov_b32 s82, 1.0
    s_cmp_eq_u32 s78, 1
    s_cselect_b32 s79, 0x43800000, s79
    s_cselect_b32 s81, 0x41000000, s81
    s_cmp_eq_u32 s78, 2
    s_cselect_b32 s79, 0x44000000, s79
    s_cselect_b32 s80, 0x42000000, s80
    s_cselect_b32 s81, 0x41800000, s81
    s_cselect_b32 s82, 4.0, s82
    s_cmp_eq_u32 s78, 3
    s_cselect_b32 s79, 0x44800000, s79
    s_cselect_b32 s80, 0x42800000, s80
    s_cselect_b32 s81, 0x42000000, s81
    s_cselect_b32 s82, 0x41000000, s82
    s_cmp_eq_u32 s76, 1
    s_cselect_b64 s[84:85], -1, 0
    s_lshl_b32 s86, s76, 8
    s_mul_i32 s87, s78, 4224
    s_add_u32 s86, s86, 57344
    s_add_u32 s87, s87, s86
    s_mul_i32 s88, s78, 8448
    s_add_u32 s88, s88, s86
    s_add_u32 s88, s88, 16896
    v_lshl_add_u32 v30, v1, 2, s87
    v_lshl_add_u32 v31, v1, 2, s88
    s_mov_b32 s92, 0
    s_cmp_ge_u32 s3, 1
    s_cselect_b32 s92, 1, s92
    s_cmp_ge_u32 s3, 2
    s_cselect_b32 s92, 2, s92
    s_cmp_ge_u32 s3, 4
    s_cselect_b32 s92, 3, s92
    s_lshl_b32 s93, 128, s92
    s_cmp_eq_u32 s92, 0
    s_cselect_b32 s93, 0, s93
    s_lshl_b32 s94, 8, s92
    s_max_u32 s94, s94, 16
    s_lshl_b32 s95, 1, s92
    s_lshr_b32 s95, s95, 1
    s_sub_u32 s95, s3, s95
    s_lshl_b32 s95, s95, 4
    s_add_u32 s96, s93, s95
    v_add_u32 v32, s96, v2
    v_cvt_f32_u32 v32, v32
    v_cvt_pk_bf16_f32 v32, v32, v32
    v_lshlrev_b32 v32, 16, v32
    v_cvt_u32_f32 v32, v32
    v_subrev_u32 v32, s93, v32
    v_lshrrev_b32 v36, 2, v32
    v_add_u32 v36, 12, v36
    v_lshrrev_b32 v37, 3, v32
    v_add_u32 v37, 20, v37
    v_cmp_lt_u32 vcc, 32, v32
    s_nop 1
    v_cndmask_b32 v36, v36, v37, vcc
    v_cmp_gt_u32 vcc, 16, v32
    s_nop 1
    v_cndmask_b32 v32, v36, v32, vcc
    v_mul_u32_u24 v32, 528, v32
    v_lshl_add_u32 v32, v3, 4, v32
    v_add_u32 v32, 57344, v32
    s_lshl_b32 s97, s92, 4
    s_add_u32 s97, s97, 32
    v_add_u32 v33, s97, v2
    v_mul_u32_u24 v33, 528, v33
    v_lshl_add_u32 v33, v3, 4, v33
    v_add_u32 v33, 57344, v33
    v_mul_lo_u32 v34, v2, s94
    v_lshl_add_u32 v34, v3, 2, v34
    v_add_u32 v34, s96, v34
    v_add_u32 v34, 16, v34
    v_add_u32 v35, 4, v34
    v_lshrrev_b32 v35, 6, v35
    v_lshlrev_b32 v35, 3, v35
    v_lshl_add_u32 v35, v34, 1, v35
    v_add_u32 v35, 114688, v35
    v_lshrrev_b32 v36, 6, v34
    v_lshlrev_b32 v36, 3, v36
    v_lshl_add_u32 v34, v34, 1, v36
    v_add_u32 v34, 114688, v34
    s_waitcnt vmcnt(4)
    s_and_b32 s68, s74, 0xffff0000
    v_mov_b32 v64, s68
    s_mul_i32 s72, s3, 7
    s_add_u32 s72, s72, 4
    s_lshl_b32 s72, s72, 5
    s_lshl_b32 s73, s65, 2
    s_add_u32 s72, s72, s73
    s_lshl_b32 s72, s72, 10
    s_add_u32 s72, s72, 8388608
    buffer_load_dwordx4 v[128:131], v5, s[12:15], s72 offen offset:0 sc1
    v_mul_f32 v64, 1069066811, v64
    v_exp_f32 v64, v64
    s_nop 0
    v_cvt_pk_bf16_f32 v64, v64, v64
    v_lshlrev_b32 v64, 16, v64
    v_lshlrev_b32 v66, 16, v50
    v_and_b32 v67, 0xffff0000, v50
    v_lshlrev_b32 v68, 16, v51
    v_and_b32 v69, 0xffff0000, v51
    v_lshlrev_b32 v70, 16, v52
    v_and_b32 v71, 0xffff0000, v52
    v_lshlrev_b32 v72, 16, v53
    buffer_load_dwordx4 v[132:135], v5, s[12:15], s72 offen offset:1024 sc1
    v_and_b32 v73, 0xffff0000, v53
    v_mul_f32 v66, v64, v66
    v_mul_f32 v67, v64, v67
    v_mul_f32 v68, v64, v68
    v_mul_f32 v69, v64, v69
    v_mul_f32 v74, v70, v66
    v_mul_f32 v75, v70, v68
    v_mul_f32 v76, v71, v67
    v_mul_f32 v77, v71, v69
    v_fma_f32 v74, -v72, v68, v74
    v_fma_f32 v75, v72, v66, v75
    v_fma_f32 v76, -v73, v69, v76
    buffer_load_dwordx4 v[136:139], v5, s[12:15], s72 offen offset:2048 sc1
    v_fma_f32 v77, v73, v67, v77
    v_max3_f32 v78, abs(v74), abs(v75), abs(v76)
    v_max_f32 v78, abs(v77), v78
    s_nop 1
    v_max_f32_dpp v78, v78, v78 quad_perm:[1,0,3,2] row_mask:0xf bank_mask:0xf
    s_nop 1
    v_max_f32_dpp v78, v78, v78 quad_perm:[2,3,0,1] row_mask:0xf bank_mask:0xf
    s_nop 1
    v_max_f32_dpp v78, v78, v78 row_half_mirror row_mask:0xf bank_mask:0xf
    s_nop 1
    v_max_f32_dpp v78, v78, v78 row_mirror row_mask:0xf bank_mask:0xf
    v_mov_b32 v79, v78
    s_nop 1
    v_permlane16_swap_b32 v78, v79
    v_max_f32 v78, v78, v79
    v_mov_b32 v79, v78
    s_nop 1
    v_permlane32_swap_b32 v78, v79
    buffer_load_dwordx4 v[140:143], v5, s[12:15], s72 offen offset:3072 sc1
    s_add_u32 s72, s72, 32768
    v_max_f32 v78, v78, v79
    v_lshrrev_b32 v78, 23, v78
    v_max_u32 v78, 8, v78
    v_min_u32 v78, 250, v78
    v_sub_u32 v79, 261, v78
    v_lshlrev_b32 v79, 23, v79
    v_subrev_u32 v78, 7, v78
    v_lshlrev_b32 v78, 23, v78
    s_nop 0
    v_readfirstlane_b32 s91, v78
    v_cndmask_b32 v74, v74, v76, s[84:85]
    v_cndmask_b32 v75, v75, v77, s[84:85]
    v_mul_f32 v74, v74, v79
    buffer_load_dwordx4 v[144:147], v5, s[12:15], s72 offen offset:0 sc1
    v_mul_f32 v75, v75, v79
    v_lshrrev_b32 v66, s77, v48
    v_lshlrev_b32 v66, 16, v66
    v_lshrrev_b32 v67, s77, v49
    v_lshlrev_b32 v67, 16, v67
    v_mul_f32 v66, v64, v66
    v_mul_f32 v67, v64, v67
    v_mul_f32 v66, 1069066811, v66
    v_mul_f32 v67, 1042479491, v67
    v_mul_f32 v92, s81, v66
    v_mul_f32 v93, s81, v67
    v_exp_f32 v92, v92
    buffer_load_dwordx4 v[148:151], v5, s[12:15], s72 offen offset:1024 sc1
    v_fract_f32 v93, v93
    v_cos_f32 v94, v93
    v_sin_f32 v95, v93
    v_mul_f32 v80, v92, v94
    v_mul_f32 v81, v92, v95
    v_mul_f32 v96, s82, v66
    v_mul_f32 v97, s82, v67
    v_exp_f32 v96, v96
    v_fract_f32 v97, v97
    v_cos_f32 v98, v97
    v_sin_f32 v99, v97
    v_mul_f32 v82, v96, v98
    buffer_load_dwordx4 v[152:155], v5, s[12:15], s72 offen offset:2048 sc1
    v_mul_f32 v83, v96, v99
    v_mul_f32 v100, s79, v66
    v_mul_f32 v101, s79, v67
    v_exp_f32 v100, v100
    v_fract_f32 v101, v101
    v_cos_f32 v102, v101
    v_sin_f32 v103, v101
    v_mul_f32 v84, v100, v102
    v_mul_f32 v85, v100, v103
    v_mul_f32 v104, s80, v66
    v_mul_f32 v105, s80, v67
    v_exp_f32 v104, v104
    buffer_load_dwordx4 v[156:159], v5, s[12:15], s72 offen offset:3072 sc1
    s_add_u32 s72, s72, 32768
    v_fract_f32 v105, v105
    v_cos_f32 v106, v105
    v_sin_f32 v107, v105
    v_mul_f32 v86, v104, v106
    v_mul_f32 v87, v104, v107
    v_pk_mul_f32 v[108:109], v[74:75], v[84:85] op_sel:[0,0] op_sel_hi:[1,0]
    v_pk_fma_f32 v[88:89], v[74:75], v[84:85], v[108:109] op_sel:[1,1,0] op_sel_hi:[0,1,1] neg_lo:[1,0,0]
    v_pk_mul_f32 v[110:111], v[88:89], v[86:87] op_sel:[0,0] op_sel_hi:[1,0]
    v_pk_fma_f32 v[90:91], v[88:89], v[86:87], v[110:111] op_sel:[1,1,0] op_sel_hi:[0,1,1] neg_lo:[1,0,0]
    v_pk_mul_f32 v[112:113], v[86:87], v[86:87] op_sel:[0,0] op_sel_hi:[1,0]
    v_pk_fma_f32 v[84:85], v[86:87], v[86:87], v[112:113] op_sel:[1,1,0] op_sel_hi:[0,1,1] neg_lo:[1,0,0]
    v_cvt_pk_f16_f32 v114, v80, v81
    buffer_load_dwordx4 v[160:163], v5, s[12:15], s72 offen offset:0 sc1
    ds_write_b32 v30, v114 offset:0
    v_cvt_pk_f16_f32 v115, v88, -v89
    ds_write_b32 v31, v115 offset:0
    v_cvt_pk_f16_f32 v116, v90, -v91
    ds_write_b32 v31, v116 offset:528
    v_pk_mul_f32 v[108:109], v[80:81], v[82:83] op_sel:[0,0] op_sel_hi:[1,0]
    v_pk_fma_f32 v[80:81], v[80:81], v[82:83], v[108:109] op_sel:[1,1,0] op_sel_hi:[0,1,1] neg_lo:[1,0,0]
    v_pk_mul_f32 v[110:111], v[88:89], v[84:85] op_sel:[0,0] op_sel_hi:[1,0]
    v_pk_fma_f32 v[88:89], v[88:89], v[84:85], v[110:111] op_sel:[1,1,0] op_sel_hi:[0,1,1] neg_lo:[1,0,0]
    v_pk_mul_f32 v[112:113], v[90:91], v[84:85] op_sel:[0,0] op_sel_hi:[1,0]
    v_pk_fma_f32 v[90:91], v[90:91], v[84:85], v[112:113] op_sel:[1,1,0] op_sel_hi:[0,1,1] neg_lo:[1,0,0]
    v_cvt_pk_f16_f32 v114, v80, v81
    buffer_load_dwordx4 v[164:167], v5, s[12:15], s72 offen offset:1024 sc1
    ds_write_b32 v30, v114 offset:528
    v_cvt_pk_f16_f32 v115, v88, -v89
    ds_write_b32 v31, v115 offset:1056
    v_cvt_pk_f16_f32 v116, v90, -v91
    ds_write_b32 v31, v116 offset:1584
    v_pk_mul_f32 v[108:109], v[80:81], v[82:83] op_sel:[0,0] op_sel_hi:[1,0]
    v_pk_fma_f32 v[80:81], v[80:81], v[82:83], v[108:109] op_sel:[1,1,0] op_sel_hi:[0,1,1] neg_lo:[1,0,0]
    v_pk_mul_f32 v[110:111], v[88:89], v[84:85] op_sel:[0,0] op_sel_hi:[1,0]
    v_pk_fma_f32 v[88:89], v[88:89], v[84:85], v[110:111] op_sel:[1,1,0] op_sel_hi:[0,1,1] neg_lo:[1,0,0]
    v_pk_mul_f32 v[112:113], v[90:91], v[84:85] op_sel:[0,0] op_sel_hi:[1,0]
    v_pk_fma_f32 v[90:91], v[90:91], v[84:85], v[112:113] op_sel:[1,1,0] op_sel_hi:[0,1,1] neg_lo:[1,0,0]
    v_cvt_pk_f16_f32 v114, v80, v81
    buffer_load_dwordx4 v[168:171], v5, s[12:15], s72 offen offset:2048 sc1
    ds_write_b32 v30, v114 offset:1056
    v_cvt_pk_f16_f32 v115, v88, -v89
    ds_write_b32 v31, v115 offset:2112
    v_cvt_pk_f16_f32 v116, v90, -v91
    ds_write_b32 v31, v116 offset:2640
    v_pk_mul_f32 v[108:109], v[80:81], v[82:83] op_sel:[0,0] op_sel_hi:[1,0]
    v_pk_fma_f32 v[80:81], v[80:81], v[82:83], v[108:109] op_sel:[1,1,0] op_sel_hi:[0,1,1] neg_lo:[1,0,0]
    v_pk_mul_f32 v[110:111], v[88:89], v[84:85] op_sel:[0,0] op_sel_hi:[1,0]
    v_pk_fma_f32 v[88:89], v[88:89], v[84:85], v[110:111] op_sel:[1,1,0] op_sel_hi:[0,1,1] neg_lo:[1,0,0]
    v_pk_mul_f32 v[112:113], v[90:91], v[84:85] op_sel:[0,0] op_sel_hi:[1,0]
    v_pk_fma_f32 v[90:91], v[90:91], v[84:85], v[112:113] op_sel:[1,1,0] op_sel_hi:[0,1,1] neg_lo:[1,0,0]
    v_cvt_pk_f16_f32 v114, v80, v81
    buffer_load_dwordx4 v[172:175], v5, s[12:15], s72 offen offset:3072 sc1
    s_add_u32 s72, s72, 32768
    ds_write_b32 v30, v114 offset:1584
    v_cvt_pk_f16_f32 v115, v88, -v89
    ds_write_b32 v31, v115 offset:3168
    v_cvt_pk_f16_f32 v116, v90, -v91
    ds_write_b32 v31, v116 offset:3696
    v_pk_mul_f32 v[108:109], v[80:81], v[82:83] op_sel:[0,0] op_sel_hi:[1,0]
    v_pk_fma_f32 v[80:81], v[80:81], v[82:83], v[108:109] op_sel:[1,1,0] op_sel_hi:[0,1,1] neg_lo:[1,0,0]
    v_pk_mul_f32 v[110:111], v[88:89], v[84:85] op_sel:[0,0] op_sel_hi:[1,0]
    v_pk_fma_f32 v[88:89], v[88:89], v[84:85], v[110:111] op_sel:[1,1,0] op_sel_hi:[0,1,1] neg_lo:[1,0,0]
    v_pk_mul_f32 v[112:113], v[90:91], v[84:85] op_sel:[0,0] op_sel_hi:[1,0]
    v_pk_fma_f32 v[90:91], v[90:91], v[84:85], v[112:113] op_sel:[1,1,0] op_sel_hi:[0,1,1] neg_lo:[1,0,0]
    v_cvt_pk_f16_f32 v114, v80, v81
    ds_write_b32 v30, v114 offset:2112
    v_cvt_pk_f16_f32 v115, v88, -v89
    ds_write_b32 v31, v115 offset:4224
    v_cvt_pk_f16_f32 v116, v90, -v91
    ds_write_b32 v31, v116 offset:4752
    v_pk_mul_f32 v[108:109], v[80:81], v[82:83] op_sel:[0,0] op_sel_hi:[1,0]
    v_pk_fma_f32 v[80:81], v[80:81], v[82:83], v[108:109] op_sel:[1,1,0] op_sel_hi:[0,1,1] neg_lo:[1,0,0]
    v_pk_mul_f32 v[110:111], v[88:89], v[84:85] op_sel:[0,0] op_sel_hi:[1,0]
    v_pk_fma_f32 v[88:89], v[88:89], v[84:85], v[110:111] op_sel:[1,1,0] op_sel_hi:[0,1,1] neg_lo:[1,0,0]
    v_pk_mul_f32 v[112:113], v[90:91], v[84:85] op_sel:[0,0] op_sel_hi:[1,0]
    v_pk_fma_f32 v[90:91], v[90:91], v[84:85], v[112:113] op_sel:[1,1,0] op_sel_hi:[0,1,1] neg_lo:[1,0,0]
    v_cvt_pk_f16_f32 v114, v80, v81
    ds_write_b32 v30, v114 offset:2640
    v_cvt_pk_f16_f32 v115, v88, -v89
    ds_write_b32 v31, v115 offset:5280
    v_cvt_pk_f16_f32 v116, v90, -v91
    ds_write_b32 v31, v116 offset:5808
    v_pk_mul_f32 v[108:109], v[80:81], v[82:83] op_sel:[0,0] op_sel_hi:[1,0]
    v_pk_fma_f32 v[80:81], v[80:81], v[82:83], v[108:109] op_sel:[1,1,0] op_sel_hi:[0,1,1] neg_lo:[1,0,0]
    v_pk_mul_f32 v[110:111], v[88:89], v[84:85] op_sel:[0,0] op_sel_hi:[1,0]
    v_pk_fma_f32 v[88:89], v[88:89], v[84:85], v[110:111] op_sel:[1,1,0] op_sel_hi:[0,1,1] neg_lo:[1,0,0]
    v_pk_mul_f32 v[112:113], v[90:91], v[84:85] op_sel:[0,0] op_sel_hi:[1,0]
    v_pk_fma_f32 v[90:91], v[90:91], v[84:85], v[112:113] op_sel:[1,1,0] op_sel_hi:[0,1,1] neg_lo:[1,0,0]
    v_cvt_pk_f16_f32 v114, v80, v81
    ds_write_b32 v30, v114 offset:3168
    v_cvt_pk_f16_f32 v115, v88, -v89
    ds_write_b32 v31, v115 offset:6336
    v_cvt_pk_f16_f32 v116, v90, -v91
    ds_write_b32 v31, v116 offset:6864
    v_pk_mul_f32 v[108:109], v[80:81], v[82:83] op_sel:[0,0] op_sel_hi:[1,0]
    v_pk_fma_f32 v[80:81], v[80:81], v[82:83], v[108:109] op_sel:[1,1,0] op_sel_hi:[0,1,1] neg_lo:[1,0,0]
    v_pk_mul_f32 v[110:111], v[88:89], v[84:85] op_sel:[0,0] op_sel_hi:[1,0]
    v_pk_fma_f32 v[88:89], v[88:89], v[84:85], v[110:111] op_sel:[1,1,0] op_sel_hi:[0,1,1] neg_lo:[1,0,0]
    v_pk_mul_f32 v[112:113], v[90:91], v[84:85] op_sel:[0,0] op_sel_hi:[1,0]
    v_pk_fma_f32 v[90:91], v[90:91], v[84:85], v[112:113] op_sel:[1,1,0] op_sel_hi:[0,1,1] neg_lo:[1,0,0]
    v_cvt_pk_f16_f32 v114, v80, v81
    ds_write_b32 v30, v114 offset:3696
    v_cvt_pk_f16_f32 v115, v88, -v89
    ds_write_b32 v31, v115 offset:7392
    v_cvt_pk_f16_f32 v116, v90, -v91
    ds_write_b32 v31, v116 offset:7920
    s_waitcnt vmcnt(12) lgkmcnt(0)
    s_barrier
    s_cmp_lg_u32 s3, 0
    s_cbranch_scc1 LsigB_skip
    s_lshr_b32 s76, s4, 0
    s_lshl_b32 s76, s76, 8
    s_add_u32 s76, s76, 4096
    v_mov_b32 v10, s76
    v_mov_b32 v11, 1
    s_mov_b64 exec, 1
    buffer_atomic_add v11, v10, s[12:15], 0 offen sc1
    s_mov_b64 exec, -1
LsigB_skip:
    s_cmp_lg_u32 s3, 0
    s_cbranch_scc1 Lkz_skip1
    v_mul_u32_u24 v36, 4416, v3
    v_lshl_add_u32 v36, v2, 1, v36
    v_add_u32 v36, 132352, v36
    v_mov_b32 v37, 0
    ds_write_b16 v36, v37
    v_cmp_gt_u32 vcc, v3, v2
    s_nop 2
    s_and_saveexec_b64 s[96:97], vcc
    ds_write_b16 v36, v37 offset:32
    s_mov_b64 exec, s[96:97]
Lkz_skip1:
    ds_read_b128 v[64:67], v32 offset:0
    ds_read_b128 v[68:71], v33 offset:0
    ds_read_b128 v[72:75], v32 offset:64
    ds_read_b128 v[76:79], v33 offset:64
    ds_read_b128 v[80:83], v32 offset:128
    ds_read_b128 v[84:87], v33 offset:128
    ds_read_b128 v[88:91], v32 offset:192
    ds_read_b128 v[92:95], v33 offset:192
    s_waitcnt lgkmcnt(6)
    v_mfma_f32_16x16x32_f16 v[116:119], v[64:67], v[68:71], 0
    s_waitcnt lgkmcnt(4)
    v_mfma_f32_16x16x32_f16 v[116:119], v[72:75], v[76:79], v[116:119]
    s_waitcnt lgkmcnt(2)
    v_mfma_f32_16x16x32_f16 v[116:119], v[80:83], v[84:87], v[116:119]
    s_waitcnt lgkmcnt(0)
    v_mfma_f32_16x16x32_f16 v[116:119], v[88:91], v[92:95], v[116:119]
    ds_read_b128 v[64:67], v32 offset:256
    ds_read_b128 v[68:71], v33 offset:256
    ds_read_b128 v[72:75], v32 offset:320
    ds_read_b128 v[76:79], v33 offset:320
    ds_read_b128 v[80:83], v32 offset:384
    ds_read_b128 v[84:87], v33 offset:384
    ds_read_b128 v[88:91], v32 offset:448
    ds_read_b128 v[92:95], v33 offset:448
    s_waitcnt lgkmcnt(6)
    v_mfma_f32_16x16x32_f16 v[116:119], v[64:67], v[68:71], v[116:119]
    s_waitcnt lgkmcnt(4)
    v_mfma_f32_16x16x32_f16 v[116:119], v[72:75], v[76:79], v[116:119]
    s_waitcnt lgkmcnt(2)
    v_mfma_f32_16x16x32_f16 v[116:119], v[80:83], v[84:87], v[116:119]
    s_waitcnt lgkmcnt(0)
    v_mfma_f32_16x16x32_f16 v[116:119], v[88:91], v[92:95], v[116:119]
    s_nop 7
    v_cvt_pk_f16_f32 v108, v116, v117
    v_cvt_pk_f16_f32 v109, v118, v119
    v_alignbit_b32 v110, v109, v108, 16
    ds_write_b64 v34, v[108:109] offset:17664
    ds_write_b16 v34, v108 offset:22082
    ds_write_b32 v34, v110 offset:22084
    ds_write_b16_d16_hi v35, v109 offset:22088
    ds_write_b32 v34, v108 offset:26500
    ds_write_b32 v35, v109 offset:26504
    ds_write_b16 v34, v108 offset:30918
    ds_write_b32 v35, v110 offset:30920
    ds_write_b16_d16_hi v35, v109 offset:30924
    v_sub_u32 v23, 3, v2
    v_and_b32 v23, 3, v23
    v_mul_u32_u24 v20, 4416, v23
    v_add_u32 v23, v23, v2
    v_lshlrev_b32 v24, 3, v3
    v_sub_u32 v23, v23, v24
    v_add_u32 v23, 25, v23
    v_lshl_add_u32 v20, v23, 1, v20
    s_lshl_b32 s87, s3, 6
    s_add_u32 s87, s87, 132352
    v_add_u32 v20, s87, v20
    s_lshl_b32 s88, s3, 5
    v_add_u32 v23, s88, v23
    v_add_u32 v24, 4, v23
    v_lshrrev_b32 v24, 6, v24
    v_lshl_add_u32 v21, v24, 3, v20
    v_add_u32 v21, 8, v21
    v_lshrrev_b32 v23, 6, v23
    v_lshl_add_u32 v20, v23, 3, v20
    v_lshlrev_b32 v22, 5, v2
    v_lshl_add_u32 v22, v3, 4, v22
    s_lshl_b32 s88, s3, 6
    s_add_u32 s88, s88, 155920
    v_sub_u32 v22, s88, v22
    s_waitcnt lgkmcnt(0)
    s_barrier
    ds_read_b64 v[64:65], v20 offset:0
    ds_read_b64 v[66:67], v21 offset:0
    ds_read_b128 v[96:99], v22 offset:3584
    ds_read_b64 v[68:69], v20 offset:544
    ds_read_b64 v[70:71], v21 offset:544
    ds_read_b128 v[100:103], v22 offset:3072
    ds_read_b64 v[72:73], v20 offset:1088
    ds_read_b64 v[74:75], v21 offset:1088
    ds_read_b128 v[104:107], v22 offset:2560
    ds_read_b64 v[76:77], v20 offset:1632
    ds_read_b64 v[78:79], v21 offset:1632
    ds_read_b128 v[108:111], v22 offset:2048
    ds_read_b64 v[80:81], v20 offset:2176
    ds_read_b64 v[82:83], v21 offset:2176
    ds_read_b128 v[112:115], v22 offset:1536
    ds_read_b64 v[84:85], v20 offset:2720
    ds_read_b64 v[86:87], v21 offset:2720
    ds_read_b128 v[116:119], v22 offset:1024
    ds_read_b64 v[88:89], v20 offset:3264
    ds_read_b64 v[90:91], v21 offset:3264
    ds_read_b128 v[120:123], v22 offset:512
    ds_read_b64 v[92:93], v20 offset:3808
    ds_read_b64 v[94:95], v21 offset:3808
    ds_read_b128 v[124:127], v22 offset:0
    s_waitcnt lgkmcnt(15)
    v_mfma_f32_16x16x32_f16 v[32:35], v[64:67], v[96:99], 0
    s_waitcnt lgkmcnt(15)
    v_mfma_f32_16x16x32_f16 v[36:39], v[64:67], v[100:103], 0
    v_mfma_f32_16x16x32_f16 v[36:39], v[68:71], v[96:99], v[36:39]
    v_mfma_f32_16x16x32_f16 v[40:43], v[68:71], v[100:103], 0
    s_waitcnt lgkmcnt(15)
    v_mfma_f32_16x16x32_f16 v[40:43], v[64:67], v[104:107], v[40:43]
    v_mfma_f32_16x16x32_f16 v[40:43], v[72:75], v[96:99], v[40:43]
    v_mfma_f32_16x16x32_f16 v[44:47], v[68:71], v[104:107], 0
    v_mfma_f32_16x16x32_f16 v[44:47], v[72:75], v[100:103], v[44:47]
    v_mfma_f32_16x16x32_f16 v[48:51], v[72:75], v[104:107], 0
    s_waitcnt lgkmcnt(12)
    v_mfma_f32_16x16x32_f16 v[44:47], v[64:67], v[108:111], v[44:47]
    v_mfma_f32_16x16x32_f16 v[44:47], v[76:79], v[96:99], v[44:47]
    v_mfma_f32_16x16x32_f16 v[48:51], v[68:71], v[108:111], v[48:51]
    v_mfma_f32_16x16x32_f16 v[48:51], v[76:79], v[100:103], v[48:51]
    v_mfma_f32_16x16x32_f16 v[52:55], v[72:75], v[108:111], 0
    v_mfma_f32_16x16x32_f16 v[52:55], v[76:79], v[104:107], v[52:55]
    v_mfma_f32_16x16x32_f16 v[56:59], v[76:79], v[108:111], 0
    s_waitcnt lgkmcnt(9)
    v_mfma_f32_16x16x32_f16 v[48:51], v[64:67], v[112:115], v[48:51]
    v_mfma_f32_16x16x32_f16 v[48:51], v[80:83], v[96:99], v[48:51]
    v_mfma_f32_16x16x32_f16 v[52:55], v[68:71], v[112:115], v[52:55]
    v_mfma_f32_16x16x32_f16 v[52:55], v[80:83], v[100:103], v[52:55]
    v_mfma_f32_16x16x32_f16 v[56:59], v[72:75], v[112:115], v[56:59]
    v_mfma_f32_16x16x32_f16 v[56:59], v[80:83], v[104:107], v[56:59]
    v_mfma_f32_16x16x32_f16 v[60:63], v[76:79], v[112:115], 0
    v_mfma_f32_16x16x32_f16 v[60:63], v[80:83], v[108:111], v[60:63]
    s_waitcnt lgkmcnt(6)
    v_mfma_f32_16x16x32_f16 v[52:55], v[64:67], v[116:119], v[52:55]
    v_mfma_f32_16x16x32_f16 v[52:55], v[84:87], v[96:99], v[52:55]
    v_mfma_f32_16x16x32_f16 v[56:59], v[68:71], v[116:119], v[56:59]
    v_mfma_f32_16x16x32_f16 v[56:59], v[84:87], v[100:103], v[56:59]
    v_mfma_f32_16x16x32_f16 v[60:63], v[72:75], v[116:119], v[60:63]
    v_mfma_f32_16x16x32_f16 v[60:63], v[84:87], v[104:107], v[60:63]
    s_waitcnt lgkmcnt(3)
    v_mfma_f32_16x16x32_f16 v[56:59], v[64:67], v[120:123], v[56:59]
    v_mfma_f32_16x16x32_f16 v[56:59], v[88:91], v[96:99], v[56:59]
    v_mfma_f32_16x16x32_f16 v[60:63], v[68:71], v[120:123], v[60:63]
    v_mfma_f32_16x16x32_f16 v[60:63], v[88:91], v[100:103], v[60:63]
    s_waitcnt lgkmcnt(0)
    v_mfma_f32_16x16x32_f16 v[60:63], v[64:67], v[124:127], v[60:63]
    v_mfma_f32_16x16x32_f16 v[60:63], v[92:95], v[96:99], v[60:63]
    s_lshl_b32 s84, s3, 13
    v_add_u32 v6, s84, v5
    ds_write_b128 v6, v[32:35] offset:0
    ds_write_b128 v6, v[36:39] offset:1024
    ds_write_b128 v6, v[40:43] offset:2048
    ds_write_b128 v6, v[44:47] offset:3072
    ds_write_b128 v6, v[48:51] offset:4096
    ds_write_b128 v6, v[52:55] offset:5120
    ds_write_b128 v6, v[56:59] offset:6144
    ds_write_b128 v6, v[60:63] offset:7168
    s_lshl_b32 s84, s3, 10
    s_mov_b32 s85, 8192
    v_add_u32 v7, s84, v5
    v_lshlrev_b32 v14, 4, v2
    v_lshl_add_u32 v14, v3, 2, v14
    s_lshl_b32 s86, s3, 8
    v_add_u32 v14, s86, v14
    v_lshlrev_b32 v15, 1, v14
    v_sub_u32 v16, 159480, v15
    ds_read_b64 v[24:25], v16
    s_lshl_b32 s79, s67, 1
    s_add_u32 s79, s79, 1
    s_lshl_b32 s80, s79, 12
    s_add_u32 s88, s80, 33554432
    s_and_b32 s86, s89, 0xffff0000
    s_waitcnt lgkmcnt(0)
    s_barrier
    ds_read_b128 v[64:67], v7
    v_add_u32 v7, s85, v7
    ds_read_b128 v[68:71], v7
    v_add_u32 v7, s85, v7
    ds_read_b128 v[72:75], v7
    v_add_u32 v7, s85, v7
    ds_read_b128 v[76:79], v7
    v_add_u32 v7, s85, v7
    ds_read_b128 v[80:83], v7
    v_add_u32 v7, s85, v7
    ds_read_b128 v[84:87], v7
    v_add_u32 v7, s85, v7
    ds_read_b128 v[88:91], v7
    v_add_u32 v7, s85, v7
    ds_read_b128 v[92:95], v7
    s_waitcnt lgkmcnt(0)
    v_add_f32 v64, v64, v68
    v_add_f32 v72, v72, v76
    v_add_f32 v80, v80, v84
    v_add_f32 v88, v88, v92
    v_add_f32 v64, v64, v72
    v_add_f32 v80, v80, v88
    v_add_f32 v64, v64, v80
    v_mul_f32 v64, s91, v64
    v_add_f32 v65, v65, v69
    v_add_f32 v73, v73, v77
    v_add_f32 v81, v81, v85
    v_add_f32 v89, v89, v93
    v_add_f32 v65, v65, v73
    v_add_f32 v81, v81, v89
    v_add_f32 v65, v65, v81
    v_mul_f32 v65, s91, v65
    v_add_f32 v66, v66, v70
    v_add_f32 v74, v74, v78
    v_add_f32 v82, v82, v86
    v_add_f32 v90, v90, v94
    v_add_f32 v66, v66, v74
    v_add_f32 v82, v82, v90
    v_add_f32 v66, v66, v82
    v_mul_f32 v66, s91, v66
    v_add_f32 v67, v67, v71
    v_add_f32 v75, v75, v79
    v_add_f32 v83, v83, v87
    v_add_f32 v91, v91, v95
    v_add_f32 v67, v67, v75
    v_add_f32 v83, v83, v91
    v_add_f32 v67, v67, v83
    v_mul_f32 v67, s91, v67
    v_cvt_f32_f16 v20, v25
    v_lshrrev_b32 v21, 16, v25
    v_cvt_f32_f16 v21, v21
    v_cvt_f32_f16 v22, v24
    v_lshrrev_b32 v23, 16, v24
    v_cvt_f32_f16 v23, v23
    v_mul_f32 v21, s86, v21
    v_mul_f32 v20, s86, v20
    v_mul_f32 v23, s86, v23
    v_mul_f32 v22, s86, v22
    v_cvt_pk_bf16_f32 v24, v21, v20
    v_cvt_pk_bf16_f32 v25, v23, v22
    v_cvt_pk_bf16_f32 v26, v64, v65
    v_cvt_pk_bf16_f32 v27, v66, v67
    v_lshlrev_b32 v20, 16, v24
    v_and_b32 v21, 0xffff0000, v24
    v_lshlrev_b32 v22, 16, v25
    v_and_b32 v23, 0xffff0000, v25
    v_lshlrev_b32 v28, 16, v26
    v_and_b32 v29, 0xffff0000, v26
    v_lshlrev_b32 v30, 16, v27
    v_and_b32 v31, 0xffff0000, v27
    v_add_f32 v20, v20, v28
    v_add_f32 v21, v21, v29
    v_add_f32 v22, v22, v30
    v_add_f32 v23, v23, v31
    v_cvt_pk_bf16_f32 v12, v20, v21
    v_cvt_pk_bf16_f32 v13, v22, v23
    buffer_store_dwordx2 v[12:13], v15, s[12:15], s88 offen sc1
    s_lshr_b32 s76, s64, 1
    s_lshl_b32 s76, s76, 8
    s_add_u32 s76, s76, 4096
    v_mov_b32 v10, s76
    s_mov_b32 s99, 0
LwaitB:
    buffer_load_dword v11, v10, s[12:15], 0 offen sc1
    s_waitcnt vmcnt(0)
    v_cmp_gt_u32 vcc, 16, v11
    s_nop 4
    s_cbranch_vccz LwaitB_ok
    s_sleep 1
    s_add_u32 s99, s99, 1
    s_cmp_lt_u32 s99, 0x8000
    s_cbranch_scc1 LwaitB
LwaitB_ok:
    v_mov_b32 v10, 150048
    v_mov_b32 v11, 1
    s_mov_b64 exec, 1
    ds_add_rtn_u32 v12, v10, v11
    s_waitcnt lgkmcnt(0)
    v_readfirstlane_b32 s76, v12
    s_mov_b64 exec, -1
    s_nop 1
    s_cmp_lg_u32 s76, 7
    s_cbranch_scc1 LsigC_skip
    s_lshr_b32 s76, s67, 5
    s_lshl_b32 s76, s76, 8
    s_add_u32 s76, s76, 8192
    v_mov_b32 v10, s76
    v_mov_b32 v11, 1
    s_mov_b64 exec, 1
    buffer_atomic_add v11, v10, s[12:15], 0 offen sc1
    s_mov_b64 exec, -1
LsigC_skip:
    s_barrier
    s_mul_i32 s76, s3, 7
    s_lshl_b32 s77, s64, 2
    s_mul_i32 s77, s77, 56
    s_add_u32 s77, s77, s76
    s_lshl_b32 s77, s77, 10
    s_add_u32 s80, s77, 16777216
    s_add_u32 s81, s80, 57344
    s_add_u32 s82, s80, 114688
    s_add_u32 s83, s80, 172032
    buffer_load_dwordx4 v[32:35], v5, s[12:15], s80 offen offset:0 sc1
    buffer_load_dwordx4 v[36:39], v5, s[12:15], s81 offen offset:0 sc1
    buffer_load_dwordx4 v[40:43], v5, s[12:15], s82 offen offset:0 sc1
    buffer_load_dwordx4 v[44:47], v5, s[12:15], s83 offen offset:0 sc1
    buffer_load_dwordx4 v[48:51], v5, s[12:15], s80 offen offset:1024 sc1
    buffer_load_dwordx4 v[52:55], v5, s[12:15], s81 offen offset:1024 sc1
    buffer_load_dwordx4 v[56:59], v5, s[12:15], s82 offen offset:1024 sc1
    buffer_load_dwordx4 v[60:63], v5, s[12:15], s83 offen offset:1024 sc1
    buffer_load_dwordx4 v[176:179], v5, s[12:15], s80 offen offset:2048 sc1
    buffer_load_dwordx4 v[180:183], v5, s[12:15], s81 offen offset:2048 sc1
    buffer_load_dwordx4 v[184:187], v5, s[12:15], s82 offen offset:2048 sc1
    buffer_load_dwordx4 v[188:191], v5, s[12:15], s83 offen offset:2048 sc1
    s_waitcnt vmcnt(8)
    v_mfma_f32_16x16x32_bf16 v[64:67], v[192:195], v[32:35], 0
    v_mfma_f32_16x16x32_bf16 v[68:71], v[192:195], v[36:39], 0
    v_mfma_f32_16x16x32_bf16 v[72:75], v[192:195], v[40:43], 0
    v_mfma_f32_16x16x32_bf16 v[76:79], v[192:195], v[44:47], 0
    v_mfma_f32_16x16x32_bf16 v[80:83], v[196:199], v[32:35], 0
    v_mfma_f32_16x16x32_bf16 v[84:87], v[196:199], v[36:39], 0
    v_mfma_f32_16x16x32_bf16 v[88:91], v[196:199], v[40:43], 0
    v_mfma_f32_16x16x32_bf16 v[92:95], v[196:199], v[44:47], 0
    v_mfma_f32_16x16x32_bf16 v[96:99], v[200:203], v[32:35], 0
    v_mfma_f32_16x16x32_bf16 v[100:103], v[200:203], v[36:39], 0
    v_mfma_f32_16x16x32_bf16 v[104:107], v[200:203], v[40:43], 0
    v_mfma_f32_16x16x32_bf16 v[108:111], v[200:203], v[44:47], 0
    v_mfma_f32_16x16x32_bf16 v[112:115], v[204:207], v[32:35], 0
    v_mfma_f32_16x16x32_bf16 v[116:119], v[204:207], v[36:39], 0
    v_mfma_f32_16x16x32_bf16 v[120:123], v[204:207], v[40:43], 0
    v_mfma_f32_16x16x32_bf16 v[124:127], v[204:207], v[44:47], 0
    buffer_load_dwordx4 v[32:35], v5, s[12:15], s80 offen offset:3072 sc1
    s_add_u32 s80, s80, 4096
    buffer_load_dwordx4 v[36:39], v5, s[12:15], s81 offen offset:3072 sc1
    s_add_u32 s81, s81, 4096
    buffer_load_dwordx4 v[40:43], v5, s[12:15], s82 offen offset:3072 sc1
    s_add_u32 s82, s82, 4096
    buffer_load_dwordx4 v[44:47], v5, s[12:15], s83 offen offset:3072 sc1
    s_add_u32 s83, s83, 4096
    s_waitcnt vmcnt(8)
    v_mfma_f32_16x16x32_bf16 v[64:67], v[208:211], v[48:51], v[64:67]
    v_mfma_f32_16x16x32_bf16 v[68:71], v[208:211], v[52:55], v[68:71]
    v_mfma_f32_16x16x32_bf16 v[72:75], v[208:211], v[56:59], v[72:75]
    v_mfma_f32_16x16x32_bf16 v[76:79], v[208:211], v[60:63], v[76:79]
    v_mfma_f32_16x16x32_bf16 v[80:83], v[212:215], v[48:51], v[80:83]
    v_mfma_f32_16x16x32_bf16 v[84:87], v[212:215], v[52:55], v[84:87]
    v_mfma_f32_16x16x32_bf16 v[88:91], v[212:215], v[56:59], v[88:91]
    v_mfma_f32_16x16x32_bf16 v[92:95], v[212:215], v[60:63], v[92:95]
    v_mfma_f32_16x16x32_bf16 v[96:99], v[216:219], v[48:51], v[96:99]
    v_mfma_f32_16x16x32_bf16 v[100:103], v[216:219], v[52:55], v[100:103]
    v_mfma_f32_16x16x32_bf16 v[104:107], v[216:219], v[56:59], v[104:107]
    v_mfma_f32_16x16x32_bf16 v[108:111], v[216:219], v[60:63], v[108:111]
    v_mfma_f32_16x16x32_bf16 v[112:115], v[220:223], v[48:51], v[112:115]
    v_mfma_f32_16x16x32_bf16 v[116:119], v[220:223], v[52:55], v[116:119]
    v_mfma_f32_16x16x32_bf16 v[120:123], v[220:223], v[56:59], v[120:123]
    v_mfma_f32_16x16x32_bf16 v[124:127], v[220:223], v[60:63], v[124:127]
    buffer_load_dwordx4 v[48:51], v5, s[12:15], s80 offen offset:0 sc1
    buffer_load_dwordx4 v[52:55], v5, s[12:15], s81 offen offset:0 sc1
    buffer_load_dwordx4 v[56:59], v5, s[12:15], s82 offen offset:0 sc1
    buffer_load_dwordx4 v[60:63], v5, s[12:15], s83 offen offset:0 sc1
    s_waitcnt vmcnt(8)
    v_mfma_f32_16x16x32_bf16 v[64:67], v[224:227], v[176:179], v[64:67]
    v_mfma_f32_16x16x32_bf16 v[68:71], v[224:227], v[180:183], v[68:71]
    v_mfma_f32_16x16x32_bf16 v[72:75], v[224:227], v[184:187], v[72:75]
    v_mfma_f32_16x16x32_bf16 v[76:79], v[224:227], v[188:191], v[76:79]
    v_mfma_f32_16x16x32_bf16 v[80:83], v[228:231], v[176:179], v[80:83]
    v_mfma_f32_16x16x32_bf16 v[84:87], v[228:231], v[180:183], v[84:87]
    v_mfma_f32_16x16x32_bf16 v[88:91], v[228:231], v[184:187], v[88:91]
    v_mfma_f32_16x16x32_bf16 v[92:95], v[228:231], v[188:191], v[92:95]
    v_mfma_f32_16x16x32_bf16 v[96:99], v[232:235], v[176:179], v[96:99]
    v_mfma_f32_16x16x32_bf16 v[100:103], v[232:235], v[180:183], v[100:103]
    v_mfma_f32_16x16x32_bf16 v[104:107], v[232:235], v[184:187], v[104:107]
    v_mfma_f32_16x16x32_bf16 v[108:111], v[232:235], v[188:191], v[108:111]
    v_mfma_f32_16x16x32_bf16 v[112:115], v[236:239], v[176:179], v[112:115]
    v_mfma_f32_16x16x32_bf16 v[116:119], v[236:239], v[180:183], v[116:119]
    v_mfma_f32_16x16x32_bf16 v[120:123], v[236:239], v[184:187], v[120:123]
    v_mfma_f32_16x16x32_bf16 v[124:127], v[236:239], v[188:191], v[124:127]
    buffer_load_dwordx4 v[176:179], v5, s[12:15], s80 offen offset:1024 sc1
    buffer_load_dwordx4 v[180:183], v5, s[12:15], s81 offen offset:1024 sc1
    buffer_load_dwordx4 v[184:187], v5, s[12:15], s82 offen offset:1024 sc1
    buffer_load_dwordx4 v[188:191], v5, s[12:15], s83 offen offset:1024 sc1
    s_waitcnt vmcnt(8)
    v_mfma_f32_16x16x32_bf16 v[64:67], v[240:243], v[32:35], v[64:67]
    v_mfma_f32_16x16x32_bf16 v[68:71], v[240:243], v[36:39], v[68:71]
    v_mfma_f32_16x16x32_bf16 v[72:75], v[240:243], v[40:43], v[72:75]
    v_mfma_f32_16x16x32_bf16 v[76:79], v[240:243], v[44:47], v[76:79]
    v_mfma_f32_16x16x32_bf16 v[80:83], v[244:247], v[32:35], v[80:83]
    v_mfma_f32_16x16x32_bf16 v[84:87], v[244:247], v[36:39], v[84:87]
    v_mfma_f32_16x16x32_bf16 v[88:91], v[244:247], v[40:43], v[88:91]
    v_mfma_f32_16x16x32_bf16 v[92:95], v[244:247], v[44:47], v[92:95]
    v_mfma_f32_16x16x32_bf16 v[96:99], v[248:251], v[32:35], v[96:99]
    v_mfma_f32_16x16x32_bf16 v[100:103], v[248:251], v[36:39], v[100:103]
    v_mfma_f32_16x16x32_bf16 v[104:107], v[248:251], v[40:43], v[104:107]
    v_mfma_f32_16x16x32_bf16 v[108:111], v[248:251], v[44:47], v[108:111]
    v_mfma_f32_16x16x32_bf16 v[112:115], v[252:255], v[32:35], v[112:115]
    v_mfma_f32_16x16x32_bf16 v[116:119], v[252:255], v[36:39], v[116:119]
    v_mfma_f32_16x16x32_bf16 v[120:123], v[252:255], v[40:43], v[120:123]
    v_mfma_f32_16x16x32_bf16 v[124:127], v[252:255], v[44:47], v[124:127]
    buffer_load_dwordx4 v[32:35], v5, s[12:15], s80 offen offset:2048 sc1
    buffer_load_dwordx4 v[36:39], v5, s[12:15], s81 offen offset:2048 sc1
    buffer_load_dwordx4 v[40:43], v5, s[12:15], s82 offen offset:2048 sc1
    buffer_load_dwordx4 v[44:47], v5, s[12:15], s83 offen offset:2048 sc1
    s_lshr_b32 s76, s3, 1
    s_lshl_b32 s77, s3, 1
    s_and_b32 s77, s77, 3
    s_lshl_b32 s78, s64, 6
    s_lshl_b32 s79, s77, 4
    s_add_u32 s78, s78, s79
    s_lshl_b32 s78, s78, 10
    s_lshl_b32 s79, s65, 7
    s_add_u32 s78, s78, s79
    s_lshl_b32 s79, s76, 5
    s_add_u32 s78, s78, s79
    s_add_u32 s79, s78, 16384
    v_lshlrev_b32 v7, 10, v2
    v_lshl_add_u32 v7, v3, 3, v7
    buffer_load_dwordx2 v[10:11], v7, s[8:11], s78 offen
    buffer_load_dwordx2 v[12:13], v7, s[8:11], s79 offen
    s_lshl_b32 s86, s65, 8
    s_add_u32 s86, s86, 8192
    v_mov_b32 v20, s86
    buffer_load_dword v21, v20, s[12:15], 0 offen sc1
    s_waitcnt vmcnt(11)
    v_mfma_f32_16x16x32_bf16 v[64:67], v[128:131], v[48:51], v[64:67]
    v_mfma_f32_16x16x32_bf16 v[68:71], v[128:131], v[52:55], v[68:71]
    v_mfma_f32_16x16x32_bf16 v[72:75], v[128:131], v[56:59], v[72:75]
    v_mfma_f32_16x16x32_bf16 v[76:79], v[128:131], v[60:63], v[76:79]
    v_mfma_f32_16x16x32_bf16 v[80:83], v[132:135], v[48:51], v[80:83]
    v_mfma_f32_16x16x32_bf16 v[84:87], v[132:135], v[52:55], v[84:87]
    v_mfma_f32_16x16x32_bf16 v[88:91], v[132:135], v[56:59], v[88:91]
    v_mfma_f32_16x16x32_bf16 v[92:95], v[132:135], v[60:63], v[92:95]
    v_mfma_f32_16x16x32_bf16 v[96:99], v[136:139], v[48:51], v[96:99]
    v_mfma_f32_16x16x32_bf16 v[100:103], v[136:139], v[52:55], v[100:103]
    v_mfma_f32_16x16x32_bf16 v[104:107], v[136:139], v[56:59], v[104:107]
    v_mfma_f32_16x16x32_bf16 v[108:111], v[136:139], v[60:63], v[108:111]
    v_mfma_f32_16x16x32_bf16 v[112:115], v[140:143], v[48:51], v[112:115]
    v_mfma_f32_16x16x32_bf16 v[116:119], v[140:143], v[52:55], v[116:119]
    v_mfma_f32_16x16x32_bf16 v[120:123], v[140:143], v[56:59], v[120:123]
    v_mfma_f32_16x16x32_bf16 v[124:127], v[140:143], v[60:63], v[124:127]
    s_waitcnt vmcnt(7)
    v_mfma_f32_16x16x32_bf16 v[64:67], v[144:147], v[176:179], v[64:67]
    v_mfma_f32_16x16x32_bf16 v[68:71], v[144:147], v[180:183], v[68:71]
    v_mfma_f32_16x16x32_bf16 v[72:75], v[144:147], v[184:187], v[72:75]
    v_mfma_f32_16x16x32_bf16 v[76:79], v[144:147], v[188:191], v[76:79]
    v_mfma_f32_16x16x32_bf16 v[80:83], v[148:151], v[176:179], v[80:83]
    v_mfma_f32_16x16x32_bf16 v[84:87], v[148:151], v[180:183], v[84:87]
    v_mfma_f32_16x16x32_bf16 v[88:91], v[148:151], v[184:187], v[88:91]
    v_mfma_f32_16x16x32_bf16 v[92:95], v[148:151], v[188:191], v[92:95]
    v_mfma_f32_16x16x32_bf16 v[96:99], v[152:155], v[176:179], v[96:99]
    v_mfma_f32_16x16x32_bf16 v[100:103], v[152:155], v[180:183], v[100:103]
    v_mfma_f32_16x16x32_bf16 v[104:107], v[152:155], v[184:187], v[104:107]
    v_mfma_f32_16x16x32_bf16 v[108:111], v[152:155], v[188:191], v[108:111]
    v_mfma_f32_16x16x32_bf16 v[112:115], v[156:159], v[176:179], v[112:115]
    v_mfma_f32_16x16x32_bf16 v[116:119], v[156:159], v[180:183], v[116:119]
    v_mfma_f32_16x16x32_bf16 v[120:123], v[156:159], v[184:187], v[120:123]
    v_mfma_f32_16x16x32_bf16 v[124:127], v[156:159], v[188:191], v[124:127]
    s_waitcnt vmcnt(3)
    v_mfma_f32_16x16x32_bf16 v[64:67], v[160:163], v[32:35], v[64:67]
    v_mfma_f32_16x16x32_bf16 v[68:71], v[160:163], v[36:39], v[68:71]
    v_mfma_f32_16x16x32_bf16 v[72:75], v[160:163], v[40:43], v[72:75]
    v_mfma_f32_16x16x32_bf16 v[76:79], v[160:163], v[44:47], v[76:79]
    v_mfma_f32_16x16x32_bf16 v[80:83], v[164:167], v[32:35], v[80:83]
    v_mfma_f32_16x16x32_bf16 v[84:87], v[164:167], v[36:39], v[84:87]
    v_mfma_f32_16x16x32_bf16 v[88:91], v[164:167], v[40:43], v[88:91]
    v_mfma_f32_16x16x32_bf16 v[92:95], v[164:167], v[44:47], v[92:95]
    v_mfma_f32_16x16x32_bf16 v[96:99], v[168:171], v[32:35], v[96:99]
    v_mfma_f32_16x16x32_bf16 v[100:103], v[168:171], v[36:39], v[100:103]
    v_mfma_f32_16x16x32_bf16 v[104:107], v[168:171], v[40:43], v[104:107]
    v_mfma_f32_16x16x32_bf16 v[108:111], v[168:171], v[44:47], v[108:111]
    v_mfma_f32_16x16x32_bf16 v[112:115], v[172:175], v[32:35], v[112:115]
    v_mfma_f32_16x16x32_bf16 v[116:119], v[172:175], v[36:39], v[116:119]
    v_mfma_f32_16x16x32_bf16 v[120:123], v[172:175], v[40:43], v[120:123]
    v_mfma_f32_16x16x32_bf16 v[124:127], v[172:175], v[44:47], v[124:127]
    s_waitcnt vmcnt(0)
    v_cmp_gt_u32 vcc, 32, v21
    s_nop 4
    s_cbranch_vccz LwaitC_ok2
    s_mov_b32 s99, 0
LwaitC:
    buffer_load_dword v21, v20, s[12:15], 0 offen sc1
    s_waitcnt vmcnt(0)
    v_cmp_gt_u32 vcc, 32, v21
    s_nop 4
    s_cbranch_vccz LwaitC_ok
    s_sleep 1
    s_add_u32 s99, s99, 1
    s_cmp_lt_u32 s99, 0x8000
    s_cbranch_scc1 LwaitC
LwaitC_ok:
LwaitC_ok2:
    v_lshrrev_b32 v8, 4, v0
    v_and_b32 v9, 15, v0
    v_lshlrev_b32 v14, 12, v8
    v_lshl_add_u32 v14, v9, 3, v14
    s_lshl_b32 s80, s65, 18
    s_lshl_b32 s81, s64, 7
    s_add_u32 s80, s80, s81
    s_add_u32 s80, s80, 33554432
    s_add_u32 s81, s80, 131072
    buffer_load_dwordx2 v[16:17], v14, s[12:15], s80 offen sc1
    buffer_load_dwordx2 v[18:19], v14, s[12:15], s81 offen sc1
    v_mul_u32_u24 v15, 144, v8
    v_lshl_add_u32 v15, v9, 3, v15
    v_add_u32 v15, 131072, v15
    s_lshl_b32 s80, s3, 14
    s_add_u32 s80, s80, 0
    v_add_u32 v6, s80, v5
    ds_write_b128 v6, v[64:67] offset:0
    ds_write_b128 v6, v[68:71] offset:1024
    ds_write_b128 v6, v[72:75] offset:2048
    ds_write_b128 v6, v[76:79] offset:3072
    ds_write_b128 v6, v[80:83] offset:4096
    ds_write_b128 v6, v[84:87] offset:5120
    ds_write_b128 v6, v[88:91] offset:6144
    ds_write_b128 v6, v[92:95] offset:7168
    ds_write_b128 v6, v[96:99] offset:8192
    ds_write_b128 v6, v[100:103] offset:9216
    ds_write_b128 v6, v[104:107] offset:10240
    ds_write_b128 v6, v[108:111] offset:11264
    ds_write_b128 v6, v[112:115] offset:12288
    ds_write_b128 v6, v[116:119] offset:13312
    ds_write_b128 v6, v[120:123] offset:14336
    ds_write_b128 v6, v[124:127] offset:15360
    s_waitcnt vmcnt(0)
    ds_write_b64 v15, v[16:17]
    ds_write_b64 v15, v[18:19] offset:4608
    s_waitcnt lgkmcnt(0)
    s_barrier
    s_lshl_b32 s80, s3, 11
    s_add_u32 s80, s80, 0
    v_add_u32 v20, s80, v5
    v_add_u32 v19, 65536, v20
    ds_read_b128 v[96:99], v20 offset:0
    ds_read_b128 v[100:103], v20 offset:16384
    ds_read_b128 v[104:107], v20 offset:32768
    ds_read_b128 v[108:111], v20 offset:49152
    ds_read_b128 v[112:115], v19 offset:0
    ds_read_b128 v[116:119], v19 offset:16384
    ds_read_b128 v[120:123], v19 offset:32768
    ds_read_b128 v[124:127], v19 offset:49152
    ds_read_b128 v[128:131], v20 offset:1024
    ds_read_b128 v[132:135], v20 offset:17408
    ds_read_b128 v[136:139], v20 offset:33792
    ds_read_b128 v[140:143], v20 offset:50176
    ds_read_b128 v[144:147], v19 offset:1024
    ds_read_b128 v[148:151], v19 offset:17408
    ds_read_b128 v[152:155], v19 offset:33792
    ds_read_b128 v[156:159], v19 offset:50176
    v_lshlrev_b32 v21, 2, v3
    s_lshl_b32 s80, s76, 4
    v_add_u32 v21, s80, v21
    v_mul_u32_u24 v21, 144, v21
    v_lshl_add_u32 v21, v2, 1, v21
    s_lshl_b32 s80, s77, 5
    s_add_u32 s80, s80, 131072
    v_add_u32 v21, s80, v21
    ds_read_u16 v64, v21 offset:0
    ds_read_u16 v65, v21 offset:144
    ds_read_u16 v66, v21 offset:288
    ds_read_u16 v67, v21 offset:432
    ds_read_u16 v68, v21 offset:32
    ds_read_u16 v69, v21 offset:176
    ds_read_u16 v70, v21 offset:320
    ds_read_u16 v71, v21 offset:464
    s_mov_b32 s82, 3216550459
    s_waitcnt lgkmcnt(0)
    v_add_f32 v96, v96, v100
    v_add_f32 v104, v104, v108
    v_add_f32 v112, v112, v116
    v_add_f32 v120, v120, v124
    v_add_f32 v96, v96, v104
    v_add_f32 v112, v112, v120
    v_add_f32 v96, v96, v112
    v_add_f32 v97, v97, v101
    v_add_f32 v105, v105, v109
    v_add_f32 v113, v113, v117
    v_add_f32 v121, v121, v125
    v_add_f32 v97, v97, v105
    v_add_f32 v113, v113, v121
    v_add_f32 v97, v97, v113
    v_add_f32 v98, v98, v102
    v_add_f32 v106, v106, v110
    v_add_f32 v114, v114, v118
    v_add_f32 v122, v122, v126
    v_add_f32 v98, v98, v106
    v_add_f32 v114, v114, v122
    v_add_f32 v98, v98, v114
    v_add_f32 v99, v99, v103
    v_add_f32 v107, v107, v111
    v_add_f32 v115, v115, v119
    v_add_f32 v123, v123, v127
    v_add_f32 v99, v99, v107
    v_add_f32 v115, v115, v123
    v_add_f32 v99, v99, v115
    v_cvt_pk_bf16_f32 v22, v96, v97
    v_lshlrev_b32 v23, 16, v22
    v_and_b32 v24, 0xffff0000, v22
    v_mul_f32 v25, s82, v23
    v_mul_f32 v26, s82, v24
    v_exp_f32 v25, v25
    v_exp_f32 v26, v26
    v_lshlrev_b32 v64, 16, v64
    v_lshlrev_b32 v65, 16, v65
    v_add_f32 v25, 1.0, v25
    v_add_f32 v26, 1.0, v26
    v_rcp_f32 v25, v25
    v_rcp_f32 v26, v26
    s_nop 0
    v_mul_f32 v25, v25, v23
    v_mul_f32 v26, v26, v24
    v_cvt_pk_bf16_f32 v22, v25, v26
    v_lshlrev_b32 v23, 16, v22
    v_and_b32 v24, 0xffff0000, v22
    v_mul_f32 v23, v23, v64
    v_mul_f32 v24, v24, v65
    v_cvt_pk_bf16_f32 v22, v23, v24
    v_lshlrev_b32 v23, 16, v22
    v_and_b32 v24, 0xffff0000, v22
    v_lshlrev_b32 v25, 16, v10
    v_and_b32 v26, 0xffff0000, v10
    v_add_f32 v23, v23, v25
    v_add_f32 v24, v24, v26
    v_cvt_pk_bf16_f32 v28, v23, v24
    v_cvt_pk_bf16_f32 v22, v98, v99
    v_lshlrev_b32 v23, 16, v22
    v_and_b32 v24, 0xffff0000, v22
    v_mul_f32 v25, s82, v23
    v_mul_f32 v26, s82, v24
    v_exp_f32 v25, v25
    v_exp_f32 v26, v26
    v_lshlrev_b32 v66, 16, v66
    v_lshlrev_b32 v67, 16, v67
    v_add_f32 v25, 1.0, v25
    v_add_f32 v26, 1.0, v26
    v_rcp_f32 v25, v25
    v_rcp_f32 v26, v26
    s_nop 0
    v_mul_f32 v25, v25, v23
    v_mul_f32 v26, v26, v24
    v_cvt_pk_bf16_f32 v22, v25, v26
    v_lshlrev_b32 v23, 16, v22
    v_and_b32 v24, 0xffff0000, v22
    v_mul_f32 v23, v23, v66
    v_mul_f32 v24, v24, v67
    v_cvt_pk_bf16_f32 v22, v23, v24
    v_lshlrev_b32 v23, 16, v22
    v_and_b32 v24, 0xffff0000, v22
    v_lshlrev_b32 v25, 16, v11
    v_and_b32 v26, 0xffff0000, v11
    v_add_f32 v23, v23, v25
    v_add_f32 v24, v24, v26
    v_cvt_pk_bf16_f32 v29, v23, v24
    buffer_store_dwordx2 v[28:29], v7, s[24:27], s78 offen
    v_add_f32 v128, v128, v132
    v_add_f32 v136, v136, v140
    v_add_f32 v144, v144, v148
    v_add_f32 v152, v152, v156
    v_add_f32 v128, v128, v136
    v_add_f32 v144, v144, v152
    v_add_f32 v128, v128, v144
    v_add_f32 v129, v129, v133
    v_add_f32 v137, v137, v141
    v_add_f32 v145, v145, v149
    v_add_f32 v153, v153, v157
    v_add_f32 v129, v129, v137
    v_add_f32 v145, v145, v153
    v_add_f32 v129, v129, v145
    v_add_f32 v130, v130, v134
    v_add_f32 v138, v138, v142
    v_add_f32 v146, v146, v150
    v_add_f32 v154, v154, v158
    v_add_f32 v130, v130, v138
    v_add_f32 v146, v146, v154
    v_add_f32 v130, v130, v146
    v_add_f32 v131, v131, v135
    v_add_f32 v139, v139, v143
    v_add_f32 v147, v147, v151
    v_add_f32 v155, v155, v159
    v_add_f32 v131, v131, v139
    v_add_f32 v147, v147, v155
    v_add_f32 v131, v131, v147
    v_cvt_pk_bf16_f32 v22, v128, v129
    v_lshlrev_b32 v23, 16, v22
    v_and_b32 v24, 0xffff0000, v22
    v_mul_f32 v25, s82, v23
    v_mul_f32 v26, s82, v24
    v_exp_f32 v25, v25
    v_exp_f32 v26, v26
    v_lshlrev_b32 v68, 16, v68
    v_lshlrev_b32 v69, 16, v69
    v_add_f32 v25, 1.0, v25
    v_add_f32 v26, 1.0, v26
    v_rcp_f32 v25, v25
    v_rcp_f32 v26, v26
    s_nop 0
    v_mul_f32 v25, v25, v23
    v_mul_f32 v26, v26, v24
    v_cvt_pk_bf16_f32 v22, v25, v26
    v_lshlrev_b32 v23, 16, v22
    v_and_b32 v24, 0xffff0000, v22
    v_mul_f32 v23, v23, v68
    v_mul_f32 v24, v24, v69
    v_cvt_pk_bf16_f32 v22, v23, v24
    v_lshlrev_b32 v23, 16, v22
    v_and_b32 v24, 0xffff0000, v22
    v_lshlrev_b32 v25, 16, v12
    v_and_b32 v26, 0xffff0000, v12
    v_add_f32 v23, v23, v25
    v_add_f32 v24, v24, v26
    v_cvt_pk_bf16_f32 v30, v23, v24
    v_cvt_pk_bf16_f32 v22, v130, v131
    v_lshlrev_b32 v23, 16, v22
    v_and_b32 v24, 0xffff0000, v22
    v_mul_f32 v25, s82, v23
    v_mul_f32 v26, s82, v24
    v_exp_f32 v25, v25
    v_exp_f32 v26, v26
    v_lshlrev_b32 v70, 16, v70
    v_lshlrev_b32 v71, 16, v71
    v_add_f32 v25, 1.0, v25
    v_add_f32 v26, 1.0, v26
    v_rcp_f32 v25, v25
    v_rcp_f32 v26, v26
    s_nop 0
    v_mul_f32 v25, v25, v23
    v_mul_f32 v26, v26, v24
    v_cvt_pk_bf16_f32 v22, v25, v26
    v_lshlrev_b32 v23, 16, v22
    v_and_b32 v24, 0xffff0000, v22
    v_mul_f32 v23, v23, v70
    v_mul_f32 v24, v24, v71
    v_cvt_pk_bf16_f32 v22, v23, v24
    v_lshlrev_b32 v23, 16, v22
    v_and_b32 v24, 0xffff0000, v22
    v_lshlrev_b32 v25, 16, v13
    v_and_b32 v26, 0xffff0000, v13
    v_add_f32 v23, v23, v25
    v_add_f32 v24, v24, v26
    v_cvt_pk_bf16_f32 v31, v23, v24
    buffer_store_dwordx2 v[30:31], v7, s[24:27], s79 offen
    s_waitcnt vmcnt(0)
Lexit:
    s_endpgm
.section .rodata,"a"
.p2align 6
.amdhsa_kernel recurrent_scan__ssm_conv_s4__glu_gated_glu__prompt_kernel
  .amdhsa_next_free_vgpr 256
  .amdhsa_next_free_sgpr 102
  .amdhsa_accum_offset 256
  .amdhsa_group_segment_fixed_size 0
  .amdhsa_kernarg_size 128
  .amdhsa_user_sgpr_count 2
  .amdhsa_user_sgpr_kernarg_segment_ptr 1
  .amdhsa_system_sgpr_workgroup_id_x 1
.end_amdhsa_kernel
```
